```python
import torch

def _softmax(x, axis=-1):
    return torch.softmax(x, dim=axis)
def _gelu(x):
    return torch.nn.functional.gelu(x, approximate="tanh")
def _silu(x):
    return torch.nn.functional.silu(x)
def _sigmoid(x):
    return torch.sigmoid(x)
def _layernorm(x, axis=-1, eps=1e-5):
    m = x.mean(dim=axis, keepdim=True)
    v = x.var(dim=axis, keepdim=True, unbiased=False)
    return (x - m) / torch.sqrt(v + eps)
def _scatter_add(tgt, idx, src, axis=0):
    return tgt.clone().index_add_(axis, idx, src)
def _segment_sum(src, seg, n):
    out = torch.zeros((n,) + src.shape[1:], dtype=src.dtype)
    return out.index_add_(0, seg, src)
def _pad(x, pw):
    flat = tuple(v for pair in reversed(pw) for v in pair)
    return torch.nn.functional.pad(x, flat)

kernel_name = 'standalone__seq2seq_rnn_t_joint__speech'

def setup_inputs():

    _w = (lambda a: (lambda t: t.to(torch.bfloat16) if t.is_floating_point() else t)(torch.as_tensor(a)))
    B, T, D, K = 2, 16000, 256, 3
    U = 8
    sc = (1.0 / (K * D)) ** 0.5
    sd = (1.0 / D) ** 0.5
    return {
        "x": _w((lambda *s: torch.randn(*s, dtype=torch.bfloat16) * 0.2)(B, T, D) * 0.5),
        "w1": _w((lambda *s: torch.randn(*s, dtype=torch.bfloat16) * 3.2)(K, D, D) * sc),
        "w2": _w((lambda *s: torch.randn(*s, dtype=torch.bfloat16) * 3.2)(K, D, D) * sc),
        "g": _w((lambda *s: torch.randn(*s, dtype=torch.bfloat16) * 3.2)(B, U, D) * 0.5),
        "w_f": _w((lambda *s: torch.randn(*s, dtype=torch.bfloat16) * 3.2)(D, D) * sd),
        "w_g": _w((lambda *s: torch.randn(*s, dtype=torch.bfloat16) * 3.2)(D, D) * sd),
        "w_o": _w((lambda *s: torch.randn(*s, dtype=torch.bfloat16) * 3.2)(D, D) * sd),
    }

def reference(x, w1, w2, g, w_f, w_g, w_o):
    B, T, D = x.shape
    K = w1.shape[0]
    pad = K // 2
    xp = _pad(x, ((0,0),(pad,pad),(0,0)))
    h = torch.zeros_like(x)
    for i in range(K):
        h = h + torch.einsum("btc,cd->btd", xp[:, i:i+T, :], w1[i])
    h = _gelu(h)[:, ::2, :]
    T1 = h.shape[1]
    hp = _pad(h, ((0,0),(pad,pad),(0,0)))
    f = torch.zeros_like(h)
    for i in range(K):
        f = f + torch.einsum("btc,cd->btd", hp[:, i:i+T1, :], w2[i])
    f = _gelu(f)[:, ::2, :]
    fe = torch.einsum("btd,de->bte", f, w_f)
    ge = torch.einsum("bud,de->bue", g, w_g)
    j = torch.tanh(fe[:, :, None, :] + ge[:, None, :, :])
    return torch.einsum("btud,dv->btuv", j, w_o)
```

```asm
; @launch grid=(254,1,1) block=(256,1,1) lds=163840
.amdgcn_target "amdgcn-amd-amdhsa--gfx950"
.text
.globl standalone__seq2seq_rnn_t_joint__speech_kernel
.p2align 8
.type standalone__seq2seq_rnn_t_joint__speech_kernel,@function
standalone__seq2seq_rnn_t_joint__speech_kernel:
  s_cmp_ge_u32 s2, 254
  s_cbranch_scc1 L_end
  s_load_dwordx16 s[4:19], s[0:1], 0
  s_load_dwordx2 s[84:85], s[0:1], 64
  s_load_dwordx2 s[80:81], s[0:1], 72
  v_lshrrev_b32 v20, 6, v0
  v_and_b32 v14, 63, v0
  s_sub_u32 s86, s2, 4
  s_cmp_ge_u32 s86, 125
  v_readfirstlane_b32 s56, v20
  s_cselect_b32 s59, 1, 0
  s_mul_i32 s69, s59, 125
  s_sub_u32 s60, s86, s69
  s_lshl_b32 s60, s60, 5
  s_and_b32 s57, s56, 1
  s_lshr_b32 s58, s56, 1
  s_getpc_b64 s[96:97]
L_pc:
  s_lshr_b32 s94, s2, 3
  s_and_b32 s94, s94, 31
  s_lshl_b32 s94, s94, 2
  s_add_u32 s94, s94, s56
  s_min_u32 s94, s94, (L_end - L_pc) / 1024
  s_lshl_b32 s94, s94, 10
  v_lshlrev_b32 v21, 4, v14
  v_add_u32 v21, s94, v21
  global_load_dwordx4 a[252:255], v21, s[96:97]
  s_mov_b32 s62, 0x05040100
  s_mov_b32 s63, 0x07060302
  s_mov_b32 s76, 0x4038aa3b
  v_lshrrev_b32 v21, 4, v14
  v_and_b32 v22, 15, v14
  v_lshrrev_b32 v23, 5, v14
  v_and_b32 v24, 31, v14
  s_lshl_b32 s69, s57, 8
  s_lshl_b32 s70, s58, 14
  s_add_u32 s69, s69, s70
  v_lshlrev_b32 v25, 12, v21
  v_lshl_add_u32 v25, v22, 4, v25
  v_add_u32 v1, s69, v25
  v_lshrrev_b32 v26, 3, v14
  v_and_b32 v25, 6, v26
  v_and_b32 v27, 7, v14
  v_xor_b32 v25, v25, v27
  v_lshlrev_b32 v26, 9, v26
  v_lshl_add_u32 v26, v25, 4, v26
  v_lshlrev_b32 v25, 4, v14
  s_mul_i32 s69, s56, 18432
  s_add_u32 s69, s69, 78848
  v_add_u32 v7, s69, v25
  s_xor_b32 s70, s56, 2
  s_mul_i32 s69, s70, 18432
  s_add_u32 s69, s69, 78848
  v_add_u32 v8, s69, v25
  s_cmp_lt_u32 s2, 4
  s_cbranch_scc1 L_prod
  s_lshl_b32 s69, s60, 11
  s_sub_u32 s69, s69, 1536
  s_lshl_b32 s72, s56, 7
  s_add_u32 s72, s72, s69
  s_add_u32 s72, s72, 65536
  s_mul_i32 s73, s56, 19584
  s_add_u32 s73, s73, 18432
  s_lshl_b32 s70, s56, 12
  s_add_u32 s69, s69, s70
  s_mul_i32 s70, s56, 1152
  s_mul_i32 s71, s59, 8192000
  s_waitcnt lgkmcnt(0)
  s_add_u32 s20, s4, s71
  s_addc_u32 s21, s5, 0
  s_and_b32 s21, s21, 0xffff
  s_mov_b32 s22, 8192000
  s_mov_b32 s23, 0x00020000
  s_lshr_b32 s94, s2, 3
  s_and_b32 s94, s94, 31
  s_lshl_b32 s94, s94, 2
  s_add_u32 s94, s94, s56
  s_mul_i32 s95, s94, 3072
  v_lshlrev_b32 v28, 4, v14
  v_add_u32 v28, s95, v28
  global_load_dwordx4 a[252:255], v28, s[6:7] offset:0
  global_load_dwordx4 a[252:255], v28, s[6:7] offset:1024
  global_load_dwordx4 a[252:255], v28, s[6:7] offset:2048
  v_add_u32 v27, s72, v26
  s_mov_b32 m0, s73
  s_nop 0
  buffer_load_dwordx4 v27, s[20:23], 0 offen nt lds
  s_mov_b32 s92, s69
  s_mov_b32 s93, s70
  v_mov_b32 v13, v26
  s_add_u32 s94, s92, 0
  s_add_u32 s95, s93, 0
  v_add_u32 v9, s94, v13
  s_mov_b32 m0, s95
  s_nop 0
  buffer_load_dwordx4 v9, s[20:23], 0 offen nt lds
  s_add_u32 s94, s92, 16384
  s_add_u32 s95, s93, 4608
  v_add_u32 v10, s94, v13
  s_mov_b32 m0, s95
  s_nop 0
  buffer_load_dwordx4 v10, s[20:23], 0 offen nt lds
  s_add_u32 s94, s92, 32768
  s_add_u32 s95, s93, 9216
  v_add_u32 v9, s94, v13
  s_mov_b32 m0, s95
  s_nop 0
  buffer_load_dwordx4 v9, s[20:23], 0 offen nt lds
  s_add_u32 s94, s92, 49152
  s_add_u32 s95, s93, 13824
  v_add_u32 v10, s94, v13
  s_mov_b32 m0, s95
  s_nop 0
  buffer_load_dwordx4 v10, s[20:23], 0 offen nt lds
  v_add_u32 v3, 0x0, v1
  global_load_dwordx4 v[64:67], v3, s[6:7] offset:0
  global_load_dwordx4 v[68:71], v3, s[6:7] offset:512
  global_load_dwordx4 v[72:75], v3, s[6:7] offset:1024
  global_load_dwordx4 v[76:79], v3, s[6:7] offset:1536
  global_load_dwordx4 v[80:83], v3, s[6:7] offset:2048
  global_load_dwordx4 v[84:87], v3, s[6:7] offset:2560
  global_load_dwordx4 v[88:91], v3, s[6:7] offset:3072
  global_load_dwordx4 v[92:95], v3, s[6:7] offset:3584
  s_mov_b32 s28, s18
  s_and_b32 s29, s19, 0xffff
  s_mov_b32 s30, 32768000
  s_mov_b32 s31, 0x00020000
  s_mov_b32 s88, s80
  s_and_b32 s89, s81, 0xffff
  s_mov_b32 s90, 720896
  s_mov_b32 s91, 0x00020000
  s_mov_b32 s64, 0xbdd2d3e8
  s_mov_b32 s65, 0xbdd2d3e8
  s_mov_b32 s66, 1.0
  v_add_u32 v3, 0x20000, v1
  global_load_dwordx4 v[96:99], v3, s[6:7] offset:0
  s_mov_b32 s67, 1.0
  s_mov_b32 s68, 0
  v_lshlrev_b32 v25, 4, v14
  s_lshl_b32 s69, s56, 12
  v_add_u32 v2, s69, v25
  s_lshl_b32 s69, s56, 11
  s_add_u32 s69, s69, 589824
  v_add_u32 v18, s69, v25
  global_load_dwordx4 v[100:103], v3, s[6:7] offset:512
  v_mov_b32 v28, 0
  v_mov_b32 v29, 0
  v_mov_b32 v30, 0
  v_mov_b32 v31, 0
  s_nop 1
  global_load_dwordx4 v[104:107], v3, s[6:7] offset:1024
  v_mfma_f32_32x32x16_bf16 a[0:15], v[28:31], v[28:31], 0
  global_load_dwordx4 v[108:111], v3, s[6:7] offset:1536
  v_mfma_f32_32x32x16_bf16 a[16:31], v[28:31], v[28:31], 0
  global_load_dwordx4 v[112:115], v3, s[6:7] offset:2048
  v_mfma_f32_32x32x16_bf16 a[32:47], v[28:31], v[28:31], 0
  global_load_dwordx4 v[116:119], v3, s[6:7] offset:2560
  v_mfma_f32_32x32x16_bf16 a[48:63], v[28:31], v[28:31], 0
  global_load_dwordx4 v[120:123], v3, s[6:7] offset:3072
  v_mfma_f32_32x32x16_bf16 a[64:79], v[28:31], v[28:31], 0
  global_load_dwordx4 v[124:127], v3, s[6:7] offset:3584
  v_mfma_f32_32x32x16_bf16 a[80:95], v[28:31], v[28:31], 0
  s_add_u32 s94, s92, 128
  s_add_u32 s95, s93, 19584
  v_add_u32 v9, s94, v13
  s_mov_b32 m0, s95
  s_nop 0
  buffer_load_dwordx4 v9, s[20:23], 0 offen nt lds
  v_mfma_f32_32x32x16_bf16 a[96:111], v[28:31], v[28:31], 0
  s_add_u32 s94, s92, 16512
  s_add_u32 s95, s93, 24192
  v_add_u32 v9, s94, v13
  s_mov_b32 m0, s95
  s_nop 0
  buffer_load_dwordx4 v9, s[20:23], 0 offen nt lds
  v_mfma_f32_32x32x16_bf16 a[112:127], v[28:31], v[28:31], 0
  s_add_u32 s94, s92, 32896
  s_add_u32 s95, s93, 28800
  v_add_u32 v9, s94, v13
  s_mov_b32 m0, s95
  s_nop 0
  buffer_load_dwordx4 v9, s[20:23], 0 offen nt lds
  v_mfma_f32_32x32x16_bf16 a[128:143], v[28:31], v[28:31], 0
  s_add_u32 s94, s92, 49280
  s_add_u32 s95, s93, 33408
  v_add_u32 v9, s94, v13
  s_mov_b32 m0, s95
  s_nop 0
  buffer_load_dwordx4 v9, s[20:23], 0 offen nt lds
  v_mfma_f32_32x32x16_bf16 a[144:159], v[28:31], v[28:31], 0
  v_add_u32 v3, 0x40000, v1
  global_load_dwordx4 v[128:131], v3, s[6:7] offset:0
  s_or_b32 s69, s60, s58
  v_or_b32 v25, s69, v21
  v_cmp_eq_u32 vcc, 0, v25
  v_mov_b32 v25, 1.0
  s_nop 1
  global_load_dwordx4 v[132:135], v3, s[6:7] offset:512
  v_cndmask_b32 v11, v25, 0, vcc
  s_lshl_b32 s69, s58, 2
  v_add_u32 v25, s69, v21
  s_mul_i32 s69, s58, 9216
  s_sub_u32 s70, 9216, s69
  v_add_u32 v26, 0, v22
  v_and_b32 v27, 3, v26
  global_load_dwordx4 v[136:139], v3, s[6:7] offset:1024
  v_lshlrev_b32 v27, 1, v27
  v_lshrrev_b32 v26, 2, v26
  v_mul_u32_u24 v26, 1152, v26
  v_lshl_add_u32 v26, v27, 7, v26
  v_xor_b32 v27, v27, v25
  v_lshl_add_u32 v26, v27, 4, v26
  global_load_dwordx4 v[140:143], v3, s[6:7] offset:1536
  v_add_u32 v4, s69, v26
  v_add_u32 v5, s70, v26
  v_add_u32 v6, 0x4800, v26
  v_add_u32 v26, 1, v22
  v_and_b32 v27, 3, v26
  v_lshlrev_b32 v27, 1, v27
  global_load_dwordx4 v[144:147], v3, s[6:7] offset:2048
  v_lshrrev_b32 v26, 2, v26
  v_mul_u32_u24 v26, 1152, v26
  v_lshl_add_u32 v26, v27, 7, v26
  v_xor_b32 v27, v27, v25
  v_lshl_add_u32 v26, v27, 4, v26
  v_add_u32 v15, s69, v26
  global_load_dwordx4 v[148:151], v3, s[6:7] offset:2560
  v_add_u32 v16, s70, v26
  v_add_u32 v17, 0x4800, v26
  s_waitcnt vmcnt(26)
  s_barrier
  global_load_dwordx4 v[152:155], v3, s[6:7] offset:3072
  ds_read_b128 a[160:163], v4 offset:0
  ds_read_b128 a[164:167], v4 offset:4608
  ds_read_b128 a[168:171], v5 offset:0
  ds_read_b128 a[172:175], v5 offset:4608
  ds_read_b128 a[176:179], v6 offset:0
  s_waitcnt vmcnt(19)
  v_perm_b32 v20, v68, v64, s62
  global_load_dwordx4 v[156:159], v3, s[6:7] offset:3584
  v_perm_b32 v21, v76, v72, s62
  v_perm_b32 v22, v84, v80, s62
  v_perm_b32 v23, v92, v88, s62
  v_perm_b32 v24, v68, v64, s63
  v_perm_b32 v25, v76, v72, s63
  v_perm_b32 v26, v84, v80, s63
  v_add_u32 v3, 0x8000, v1
  global_load_dwordx4 v[160:163], v3, s[6:7] offset:0
  v_perm_b32 v27, v92, v88, s63
  s_waitcnt lgkmcnt(0)
  v_mfma_f32_16x16x32_bf16 a[0:3], a[160:163], v[20:23], a[0:3]
  v_perm_b32 v28, v69, v65, s62
  v_perm_b32 v29, v77, v73, s62
  global_load_dwordx4 v[164:167], v3, s[6:7] offset:512
  v_mfma_f32_16x16x32_bf16 a[32:35], a[164:167], v[20:23], a[32:35]
  v_perm_b32 v30, v85, v81, s62
  v_perm_b32 v31, v93, v89, s62
  v_mfma_f32_16x16x32_bf16 a[64:67], a[168:171], v[20:23], a[64:67]
  global_load_dwordx4 v[168:171], v3, s[6:7] offset:1024
  ds_read_b128 a[180:183], v4 offset:128
  v_mfma_f32_16x16x32_bf16 a[96:99], a[172:175], v[20:23], a[96:99]
  v_mfma_f32_16x16x32_bf16 a[128:131], a[176:179], v[20:23], a[128:131]
  global_load_dwordx4 v[172:175], v3, s[6:7] offset:1536
  v_mfma_f32_16x16x32_bf16 a[4:7], a[160:163], v[24:27], a[4:7]
  v_perm_b32 v32, v69, v65, s63
  v_perm_b32 v33, v77, v73, s63
  v_mfma_f32_16x16x32_bf16 a[36:39], a[164:167], v[24:27], a[36:39]
  global_load_dwordx4 v[176:179], v3, s[6:7] offset:2048
  v_perm_b32 v34, v85, v81, s63
  v_perm_b32 v35, v93, v89, s63
  v_mfma_f32_16x16x32_bf16 a[68:71], a[168:171], v[24:27], a[68:71]
  ds_read_b128 a[184:187], v4 offset:4736
  global_load_dwordx4 v[180:183], v3, s[6:7] offset:2560
  v_mfma_f32_16x16x32_bf16 a[100:103], a[172:175], v[24:27], a[100:103]
  v_mfma_f32_16x16x32_bf16 a[132:135], a[176:179], v[24:27], a[132:135]
  v_mfma_f32_16x16x32_bf16 a[8:11], a[160:163], v[28:31], a[8:11]
  global_load_dwordx4 v[184:187], v3, s[6:7] offset:3072
  v_perm_b32 v20, v70, v66, s62
  v_perm_b32 v21, v78, v74, s62
  v_mfma_f32_16x16x32_bf16 a[40:43], a[164:167], v[28:31], a[40:43]
  v_perm_b32 v22, v86, v82, s62
  global_load_dwordx4 v[188:191], v3, s[6:7] offset:3584
  v_perm_b32 v23, v94, v90, s62
  v_mfma_f32_16x16x32_bf16 a[72:75], a[168:171], v[28:31], a[72:75]
  ds_read_b128 a[188:191], v5 offset:128
  v_mfma_f32_16x16x32_bf16 a[104:107], a[172:175], v[28:31], a[104:107]
  s_add_u32 s94, s92, 256
  s_add_u32 s95, s93, 39168
  v_add_u32 v9, s94, v13
  s_mov_b32 m0, s95
  s_nop 0
  buffer_load_dwordx4 v9, s[20:23], 0 offen nt lds
  v_mfma_f32_16x16x32_bf16 a[136:139], a[176:179], v[28:31], a[136:139]
  v_mfma_f32_16x16x32_bf16 a[12:15], a[160:163], v[32:35], a[12:15]
  v_perm_b32 v24, v70, v66, s63
  s_add_u32 s94, s92, 16640
  s_add_u32 s95, s93, 43776
  v_add_u32 v9, s94, v13
  s_mov_b32 m0, s95
  s_nop 0
  buffer_load_dwordx4 v9, s[20:23], 0 offen nt lds
  v_perm_b32 v25, v78, v74, s63
  v_mfma_f32_16x16x32_bf16 a[44:47], a[164:167], v[32:35], a[44:47]
  v_perm_b32 v26, v86, v82, s63
  v_perm_b32 v27, v94, v90, s63
  s_add_u32 s94, s92, 33024
  s_add_u32 s95, s93, 48384
  v_add_u32 v9, s94, v13
  s_mov_b32 m0, s95
  s_nop 0
  buffer_load_dwordx4 v9, s[20:23], 0 offen nt lds
  v_mfma_f32_16x16x32_bf16 a[76:79], a[168:171], v[32:35], a[76:79]
  ds_read_b128 a[192:195], v5 offset:4736
  v_mfma_f32_16x16x32_bf16 a[108:111], a[172:175], v[32:35], a[108:111]
  s_add_u32 s94, s92, 49408
  s_add_u32 s95, s93, 52992
  v_add_u32 v9, s94, v13
  s_mov_b32 m0, s95
  s_nop 0
  buffer_load_dwordx4 v9, s[20:23], 0 offen nt lds
  v_mfma_f32_16x16x32_bf16 a[140:143], a[176:179], v[32:35], a[140:143]
  v_mfma_f32_16x16x32_bf16 a[16:19], a[160:163], v[20:23], a[16:19]
  v_perm_b32 v28, v71, v67, s62
  v_add_u32 v3, 0x28000, v1
  global_load_dwordx4 v[192:195], v3, s[6:7] offset:0
  v_perm_b32 v29, v79, v75, s62
  v_mfma_f32_16x16x32_bf16 a[48:51], a[164:167], v[20:23], a[48:51]
  v_perm_b32 v30, v87, v83, s62
  v_perm_b32 v31, v95, v91, s62
  global_load_dwordx4 v[196:199], v3, s[6:7] offset:512
  v_mfma_f32_16x16x32_bf16 a[80:83], a[168:171], v[20:23], a[80:83]
  ds_read_b128 a[196:199], v6 offset:128
  v_mfma_f32_16x16x32_bf16 a[112:115], a[172:175], v[20:23], a[112:115]
  global_load_dwordx4 v[200:203], v3, s[6:7] offset:1024
  v_mfma_f32_16x16x32_bf16 a[144:147], a[176:179], v[20:23], a[144:147]
  v_mfma_f32_16x16x32_bf16 a[20:23], a[160:163], v[24:27], a[20:23]
  v_perm_b32 v32, v71, v67, s63
  global_load_dwordx4 v[204:207], v3, s[6:7] offset:1536
  v_perm_b32 v33, v79, v75, s63
  v_mfma_f32_16x16x32_bf16 a[52:55], a[164:167], v[24:27], a[52:55]
  v_perm_b32 v34, v87, v83, s63
  v_perm_b32 v35, v95, v91, s63
  global_load_dwordx4 v[208:211], v3, s[6:7] offset:2048
  v_mfma_f32_16x16x32_bf16 a[84:87], a[168:171], v[24:27], a[84:87]
  v_mfma_f32_16x16x32_bf16 a[116:119], a[172:175], v[24:27], a[116:119]
  v_mfma_f32_16x16x32_bf16 a[148:151], a[176:179], v[24:27], a[148:151]
  global_load_dwordx4 v[212:215], v3, s[6:7] offset:2560
  v_mfma_f32_16x16x32_bf16 a[24:27], a[160:163], v[28:31], a[24:27]
  s_waitcnt vmcnt(30)
  v_perm_b32 v20, v100, v96, s62
  v_mfma_f32_16x16x32_bf16 a[56:59], a[164:167], v[28:31], a[56:59]
  global_load_dwordx4 v[216:219], v3, s[6:7] offset:3072
  v_perm_b32 v21, v108, v104, s62
  v_perm_b32 v22, v116, v112, s62
  v_mfma_f32_16x16x32_bf16 a[88:91], a[168:171], v[28:31], a[88:91]
  v_perm_b32 v23, v124, v120, s62
  global_load_dwordx4 v[220:223], v3, s[6:7] offset:3584
  v_mfma_f32_16x16x32_bf16 a[120:123], a[172:175], v[28:31], a[120:123]
  v_mfma_f32_16x16x32_bf16 a[152:155], a[176:179], v[28:31], a[152:155]
  v_mfma_f32_16x16x32_bf16 a[28:31], a[160:163], v[32:35], a[28:31]
  v_add_u32 v3, 0x48000, v1
  global_load_dwordx4 v[224:227], v3, s[6:7] offset:0
  v_perm_b32 v24, v100, v96, s63
  v_perm_b32 v25, v108, v104, s63
  v_mfma_f32_16x16x32_bf16 a[60:63], a[164:167], v[32:35], a[60:63]
  v_perm_b32 v26, v116, v112, s63
  global_load_dwordx4 v[228:231], v3, s[6:7] offset:512
  v_perm_b32 v27, v124, v120, s63
  v_mfma_f32_16x16x32_bf16 a[92:95], a[168:171], v[32:35], a[92:95]
  v_mfma_f32_16x16x32_bf16 a[124:127], a[172:175], v[32:35], a[124:127]
  global_load_dwordx4 v[232:235], v3, s[6:7] offset:1024
  v_mfma_f32_16x16x32_bf16 a[156:159], a[176:179], v[32:35], a[156:159]
  s_waitcnt lgkmcnt(0)
  v_mfma_f32_16x16x32_bf16 a[0:3], a[180:183], v[20:23], a[0:3]
  global_load_dwordx4 v[236:239], v3, s[6:7] offset:1536
  v_perm_b32 v28, v101, v97, s62
  v_perm_b32 v29, v109, v105, s62
  v_mfma_f32_16x16x32_bf16 a[32:35], a[184:187], v[20:23], a[32:35]
  v_perm_b32 v30, v117, v113, s62
  global_load_dwordx4 v[240:243], v3, s[6:7] offset:2048
  v_perm_b32 v31, v125, v121, s62
  v_mfma_f32_16x16x32_bf16 a[64:67], a[188:191], v[20:23], a[64:67]
  ds_read_b128 a[160:163], v15 offset:0
  v_mfma_f32_16x16x32_bf16 a[96:99], a[192:195], v[20:23], a[96:99]
  global_load_dwordx4 v[244:247], v3, s[6:7] offset:2560
  v_mfma_f32_16x16x32_bf16 a[128:131], a[196:199], v[20:23], a[128:131]
  v_mfma_f32_16x16x32_bf16 a[4:7], a[180:183], v[24:27], a[4:7]
  v_perm_b32 v32, v101, v97, s63
  global_load_dwordx4 v[248:251], v3, s[6:7] offset:3072
  v_perm_b32 v33, v109, v105, s63
  v_mfma_f32_16x16x32_bf16 a[36:39], a[184:187], v[24:27], a[36:39]
  v_perm_b32 v34, v117, v113, s63
  v_perm_b32 v35, v125, v121, s63
  global_load_dwordx4 v[252:255], v3, s[6:7] offset:3584
  v_mfma_f32_16x16x32_bf16 a[68:71], a[188:191], v[24:27], a[68:71]
  ds_read_b128 a[164:167], v15 offset:4608
  v_mfma_f32_16x16x32_bf16 a[100:103], a[192:195], v[24:27], a[100:103]
  s_add_u32 s94, s92, 384
  s_add_u32 s95, s93, 58752
  v_add_u32 v9, s94, v13
  s_mov_b32 m0, s95
  s_nop 0
  buffer_load_dwordx4 v9, s[20:23], 0 offen nt lds
  v_mfma_f32_16x16x32_bf16 a[132:135], a[196:199], v[24:27], a[132:135]
  v_mfma_f32_16x16x32_bf16 a[8:11], a[180:183], v[28:31], a[8:11]
  v_perm_b32 v20, v102, v98, s62
  s_add_u32 s94, s92, 16768
  s_add_u32 s95, s93, 63360
  v_add_u32 v9, s94, v13
  s_mov_b32 m0, s95
  s_nop 0
  buffer_load_dwordx4 v9, s[20:23], 0 offen nt lds
  v_perm_b32 v21, v110, v106, s62
  v_mfma_f32_16x16x32_bf16 a[40:43], a[184:187], v[28:31], a[40:43]
  v_perm_b32 v22, v118, v114, s62
  v_perm_b32 v23, v126, v122, s62
  s_add_u32 s94, s92, 33152
  s_add_u32 s95, s93, 67968
  v_add_u32 v9, s94, v13
  s_mov_b32 m0, s95
  s_nop 0
  buffer_load_dwordx4 v9, s[20:23], 0 offen nt lds
  v_mfma_f32_16x16x32_bf16 a[72:75], a[188:191], v[28:31], a[72:75]
  ds_read_b128 a[168:171], v16 offset:0
  v_mfma_f32_16x16x32_bf16 a[104:107], a[192:195], v[28:31], a[104:107]
  s_add_u32 s94, s92, 49536
  s_add_u32 s95, s93, 72576
  v_add_u32 v9, s94, v13
  s_mov_b32 m0, s95
  s_nop 0
  buffer_load_dwordx4 v9, s[20:23], 0 offen nt lds
  v_mfma_f32_16x16x32_bf16 a[136:139], a[196:199], v[28:31], a[136:139]
  v_mfma_f32_16x16x32_bf16 a[12:15], a[180:183], v[32:35], a[12:15]
  v_perm_b32 v24, v102, v98, s63
  v_perm_b32 v25, v110, v106, s63
  v_mfma_f32_16x16x32_bf16 a[44:47], a[184:187], v[32:35], a[44:47]
  v_perm_b32 v26, v118, v114, s63
  v_perm_b32 v27, v126, v122, s63
  v_mfma_f32_16x16x32_bf16 a[76:79], a[188:191], v[32:35], a[76:79]
  ds_read_b128 a[172:175], v16 offset:4608
  v_mfma_f32_16x16x32_bf16 a[108:111], a[192:195], v[32:35], a[108:111]
  v_mfma_f32_16x16x32_bf16 a[140:143], a[196:199], v[32:35], a[140:143]
  v_add_u32 v3, 0x10000, v1
  global_load_dwordx4 v[64:67], v3, s[6:7] offset:0
  v_mfma_f32_16x16x32_bf16 a[16:19], a[180:183], v[20:23], a[16:19]
  v_perm_b32 v28, v103, v99, s62
  v_perm_b32 v29, v111, v107, s62
  v_mfma_f32_16x16x32_bf16 a[48:51], a[184:187], v[20:23], a[48:51]
  v_perm_b32 v30, v119, v115, s62
  v_perm_b32 v31, v127, v123, s62
  v_mfma_f32_16x16x32_bf16 a[80:83], a[188:191], v[20:23], a[80:83]
  ds_read_b128 a[176:179], v17 offset:0
  v_mfma_f32_16x16x32_bf16 a[112:115], a[192:195], v[20:23], a[112:115]
  v_mfma_f32_16x16x32_bf16 a[144:147], a[196:199], v[20:23], a[144:147]
  v_mfma_f32_16x16x32_bf16 a[20:23], a[180:183], v[24:27], a[20:23]
  global_load_dwordx4 v[68:71], v3, s[6:7] offset:512
  v_perm_b32 v32, v103, v99, s63
  v_perm_b32 v33, v111, v107, s63
  v_mfma_f32_16x16x32_bf16 a[52:55], a[184:187], v[24:27], a[52:55]
  v_perm_b32 v34, v119, v115, s63
  v_perm_b32 v35, v127, v123, s63
  v_mfma_f32_16x16x32_bf16 a[84:87], a[188:191], v[24:27], a[84:87]
  v_mfma_f32_16x16x32_bf16 a[116:119], a[192:195], v[24:27], a[116:119]
  v_mfma_f32_16x16x32_bf16 a[148:151], a[196:199], v[24:27], a[148:151]
  v_mfma_f32_16x16x32_bf16 a[24:27], a[180:183], v[28:31], a[24:27]
  s_waitcnt vmcnt(34)
  v_perm_b32 v20, v132, v128, s62
  v_mfma_f32_16x16x32_bf16 a[56:59], a[184:187], v[28:31], a[56:59]
  global_load_dwordx4 v[72:75], v3, s[6:7] offset:1024
  v_perm_b32 v21, v140, v136, s62
  v_perm_b32 v22, v148, v144, s62
  v_mfma_f32_16x16x32_bf16 a[88:91], a[188:191], v[28:31], a[88:91]
  v_perm_b32 v23, v156, v152, s62
  v_mfma_f32_16x16x32_bf16 a[120:123], a[192:195], v[28:31], a[120:123]
  v_mfma_f32_16x16x32_bf16 a[152:155], a[196:199], v[28:31], a[152:155]
  v_mfma_f32_16x16x32_bf16 a[28:31], a[180:183], v[32:35], a[28:31]
  v_perm_b32 v24, v132, v128, s63
  v_perm_b32 v25, v140, v136, s63
  v_mfma_f32_16x16x32_bf16 a[60:63], a[184:187], v[32:35], a[60:63]
  v_perm_b32 v26, v148, v144, s63
  global_load_dwordx4 v[76:79], v3, s[6:7] offset:1536
  v_perm_b32 v27, v156, v152, s63
  v_mfma_f32_16x16x32_bf16 a[92:95], a[188:191], v[32:35], a[92:95]
  v_mfma_f32_16x16x32_bf16 a[124:127], a[192:195], v[32:35], a[124:127]
  v_mfma_f32_16x16x32_bf16 a[156:159], a[196:199], v[32:35], a[156:159]
  s_waitcnt vmcnt(44)
  s_barrier
  global_load_dwordx4 v[80:83], v3, s[6:7] offset:2048
  v_add_u32 v4, 0x4c80, v4
  v_add_u32 v5, 0x4c80, v5
  v_add_u32 v6, 0x4c80, v6
  s_waitcnt lgkmcnt(0)
  v_mfma_f32_16x16x32_bf16 a[0:3], a[160:163], v[20:23], a[0:3]
  v_perm_b32 v28, v133, v129, s62
  v_perm_b32 v29, v141, v137, s62
  v_mfma_f32_16x16x32_bf16 a[32:35], a[164:167], v[20:23], a[32:35]
  v_perm_b32 v30, v149, v145, s62
  v_perm_b32 v31, v157, v153, s62
  v_mfma_f32_16x16x32_bf16 a[64:67], a[168:171], v[20:23], a[64:67]
  ds_read_b128 a[180:183], v4 offset:0
  v_mfma_f32_16x16x32_bf16 a[96:99], a[172:175], v[20:23], a[96:99]
  global_load_dwordx4 v[84:87], v3, s[6:7] offset:2560
  v_mfma_f32_16x16x32_bf16 a[128:131], a[176:179], v[20:23], a[128:131]
  v_mfma_f32_16x16x32_bf16 a[4:7], a[160:163], v[24:27], a[4:7]
  v_perm_b32 v32, v133, v129, s63
  v_perm_b32 v33, v141, v137, s63
  v_mfma_f32_16x16x32_bf16 a[36:39], a[164:167], v[24:27], a[36:39]
  v_perm_b32 v34, v149, v145, s63
  v_perm_b32 v35, v157, v153, s63
  v_mfma_f32_16x16x32_bf16 a[68:71], a[168:171], v[24:27], a[68:71]
  ds_read_b128 a[184:187], v4 offset:4608
  v_mfma_f32_16x16x32_bf16 a[100:103], a[172:175], v[24:27], a[100:103]
  v_mfma_f32_16x16x32_bf16 a[132:135], a[176:179], v[24:27], a[132:135]
  global_load_dwordx4 v[88:91], v3, s[6:7] offset:3072
  v_mfma_f32_16x16x32_bf16 a[8:11], a[160:163], v[28:31], a[8:11]
  v_perm_b32 v20, v134, v130, s62
  v_perm_b32 v21, v142, v138, s62
  v_mfma_f32_16x16x32_bf16 a[40:43], a[164:167], v[28:31], a[40:43]
  v_perm_b32 v22, v150, v146, s62
  v_perm_b32 v23, v158, v154, s62
  v_mfma_f32_16x16x32_bf16 a[72:75], a[168:171], v[28:31], a[72:75]
  ds_read_b128 a[188:191], v5 offset:0
  v_mfma_f32_16x16x32_bf16 a[104:107], a[172:175], v[28:31], a[104:107]
  v_mfma_f32_16x16x32_bf16 a[136:139], a[176:179], v[28:31], a[136:139]
  v_mfma_f32_16x16x32_bf16 a[12:15], a[160:163], v[32:35], a[12:15]
  global_load_dwordx4 v[92:95], v3, s[6:7] offset:3584
  v_perm_b32 v24, v134, v130, s63
  v_perm_b32 v25, v142, v138, s63
  v_mfma_f32_16x16x32_bf16 a[44:47], a[164:167], v[32:35], a[44:47]
  v_perm_b32 v26, v150, v146, s63
  v_perm_b32 v27, v158, v154, s63
  v_mfma_f32_16x16x32_bf16 a[76:79], a[168:171], v[32:35], a[76:79]
  ds_read_b128 a[192:195], v5 offset:4608
  v_mfma_f32_16x16x32_bf16 a[108:111], a[172:175], v[32:35], a[108:111]
  v_mfma_f32_16x16x32_bf16 a[140:143], a[176:179], v[32:35], a[140:143]
  v_mfma_f32_16x16x32_bf16 a[16:19], a[160:163], v[20:23], a[16:19]
  v_perm_b32 v28, v135, v131, s62
  v_add_u32 v3, 0x30000, v1
  global_load_dwordx4 v[96:99], v3, s[6:7] offset:0
  v_perm_b32 v29, v143, v139, s62
  v_mfma_f32_16x16x32_bf16 a[48:51], a[164:167], v[20:23], a[48:51]
  v_perm_b32 v30, v151, v147, s62
  v_perm_b32 v31, v159, v155, s62
  v_mfma_f32_16x16x32_bf16 a[80:83], a[168:171], v[20:23], a[80:83]
  ds_read_b128 a[196:199], v6 offset:0
  v_mfma_f32_16x16x32_bf16 a[112:115], a[172:175], v[20:23], a[112:115]
  v_mfma_f32_16x16x32_bf16 a[144:147], a[176:179], v[20:23], a[144:147]
  v_mfma_f32_16x16x32_bf16 a[20:23], a[160:163], v[24:27], a[20:23]
  v_perm_b32 v32, v135, v131, s63
  v_perm_b32 v33, v143, v139, s63
  global_load_dwordx4 v[100:103], v3, s[6:7] offset:512
  v_mfma_f32_16x16x32_bf16 a[52:55], a[164:167], v[24:27], a[52:55]
  v_perm_b32 v34, v151, v147, s63
  v_perm_b32 v35, v159, v155, s63
  v_mfma_f32_16x16x32_bf16 a[84:87], a[168:171], v[24:27], a[84:87]
  v_mfma_f32_16x16x32_bf16 a[116:119], a[172:175], v[24:27], a[116:119]
  v_mfma_f32_16x16x32_bf16 a[148:151], a[176:179], v[24:27], a[148:151]
  v_mfma_f32_16x16x32_bf16 a[24:27], a[160:163], v[28:31], a[24:27]
  s_waitcnt vmcnt(34)
  v_perm_b32 v20, v164, v160, s62
  v_mfma_f32_16x16x32_bf16 a[56:59], a[164:167], v[28:31], a[56:59]
  global_load_dwordx4 v[104:107], v3, s[6:7] offset:1024
  v_perm_b32 v21, v172, v168, s62
  v_perm_b32 v22, v180, v176, s62
  v_mfma_f32_16x16x32_bf16 a[88:91], a[168:171], v[28:31], a[88:91]
  v_perm_b32 v23, v188, v184, s62
  v_mfma_f32_16x16x32_bf16 a[120:123], a[172:175], v[28:31], a[120:123]
  v_mfma_f32_16x16x32_bf16 a[152:155], a[176:179], v[28:31], a[152:155]
  v_mfma_f32_16x16x32_bf16 a[28:31], a[160:163], v[32:35], a[28:31]
  v_perm_b32 v24, v164, v160, s63
  v_perm_b32 v25, v172, v168, s63
  v_mfma_f32_16x16x32_bf16 a[60:63], a[164:167], v[32:35], a[60:63]
  v_perm_b32 v26, v180, v176, s63
  global_load_dwordx4 v[108:111], v3, s[6:7] offset:1536
  v_perm_b32 v27, v188, v184, s63
  v_mfma_f32_16x16x32_bf16 a[92:95], a[168:171], v[32:35], a[92:95]
  v_mfma_f32_16x16x32_bf16 a[124:127], a[172:175], v[32:35], a[124:127]
  v_mfma_f32_16x16x32_bf16 a[156:159], a[176:179], v[32:35], a[156:159]
  v_add_u32 v15, 0x4c80, v15
  v_add_u32 v16, 0x4c80, v16
  v_add_u32 v17, 0x4c80, v17
  s_waitcnt lgkmcnt(0)
  v_mfma_f32_16x16x32_bf16 a[0:3], a[180:183], v[20:23], a[0:3]
  v_perm_b32 v28, v165, v161, s62
  v_perm_b32 v29, v173, v169, s62
  v_mfma_f32_16x16x32_bf16 a[32:35], a[184:187], v[20:23], a[32:35]
  global_load_dwordx4 v[112:115], v3, s[6:7] offset:2048
  v_perm_b32 v30, v181, v177, s62
  v_perm_b32 v31, v189, v185, s62
  v_mfma_f32_16x16x32_bf16 a[64:67], a[188:191], v[20:23], a[64:67]
  ds_read_b128 a[160:163], v4 offset:128
  v_mfma_f32_16x16x32_bf16 a[96:99], a[192:195], v[20:23], a[96:99]
  v_mfma_f32_16x16x32_bf16 a[128:131], a[196:199], v[20:23], a[128:131]
  v_mfma_f32_16x16x32_bf16 a[4:7], a[180:183], v[24:27], a[4:7]
  v_perm_b32 v32, v165, v161, s63
  v_perm_b32 v33, v173, v169, s63
  v_mfma_f32_16x16x32_bf16 a[36:39], a[184:187], v[24:27], a[36:39]
  v_perm_b32 v34, v181, v177, s63
  global_load_dwordx4 v[116:119], v3, s[6:7] offset:2560
  v_perm_b32 v35, v189, v185, s63
  v_mfma_f32_16x16x32_bf16 a[68:71], a[188:191], v[24:27], a[68:71]
  ds_read_b128 a[164:167], v4 offset:4736
  v_mfma_f32_16x16x32_bf16 a[100:103], a[192:195], v[24:27], a[100:103]
  v_mfma_f32_16x16x32_bf16 a[132:135], a[196:199], v[24:27], a[132:135]
  v_mfma_f32_16x16x32_bf16 a[8:11], a[180:183], v[28:31], a[8:11]
  v_perm_b32 v20, v166, v162, s62
  v_perm_b32 v21, v174, v170, s62
  v_mfma_f32_16x16x32_bf16 a[40:43], a[184:187], v[28:31], a[40:43]
  v_perm_b32 v22, v182, v178, s62
  v_perm_b32 v23, v190, v186, s62
  global_load_dwordx4 v[120:123], v3, s[6:7] offset:3072
  v_mfma_f32_16x16x32_bf16 a[72:75], a[188:191], v[28:31], a[72:75]
  ds_read_b128 a[168:171], v5 offset:128
  v_mfma_f32_16x16x32_bf16 a[104:107], a[192:195], v[28:31], a[104:107]
  v_mfma_f32_16x16x32_bf16 a[136:139], a[196:199], v[28:31], a[136:139]
  v_mfma_f32_16x16x32_bf16 a[12:15], a[180:183], v[32:35], a[12:15]
  v_perm_b32 v24, v166, v162, s63
  v_perm_b32 v25, v174, v170, s63
  v_mfma_f32_16x16x32_bf16 a[44:47], a[184:187], v[32:35], a[44:47]
  v_perm_b32 v26, v182, v178, s63
  v_perm_b32 v27, v190, v186, s63
  v_mfma_f32_16x16x32_bf16 a[76:79], a[188:191], v[32:35], a[76:79]
  global_load_dwordx4 v[124:127], v3, s[6:7] offset:3584
  ds_read_b128 a[172:175], v5 offset:4736
  v_mfma_f32_16x16x32_bf16 a[108:111], a[192:195], v[32:35], a[108:111]
  v_mfma_f32_16x16x32_bf16 a[140:143], a[196:199], v[32:35], a[140:143]
  v_mfma_f32_16x16x32_bf16 a[16:19], a[180:183], v[20:23], a[16:19]
  v_perm_b32 v28, v167, v163, s62
  v_perm_b32 v29, v175, v171, s62
  v_mfma_f32_16x16x32_bf16 a[48:51], a[184:187], v[20:23], a[48:51]
  v_perm_b32 v30, v183, v179, s62
  v_perm_b32 v31, v191, v187, s62
  v_mfma_f32_16x16x32_bf16 a[80:83], a[188:191], v[20:23], a[80:83]
  ds_read_b128 a[176:179], v6 offset:128
  v_add_u32 v3, 0x50000, v1
  global_load_dwordx4 v[128:131], v3, s[6:7] offset:0
  v_mfma_f32_16x16x32_bf16 a[112:115], a[192:195], v[20:23], a[112:115]
  v_mfma_f32_16x16x32_bf16 a[144:147], a[196:199], v[20:23], a[144:147]
  v_mfma_f32_16x16x32_bf16 a[20:23], a[180:183], v[24:27], a[20:23]
  v_perm_b32 v32, v167, v163, s63
  v_perm_b32 v33, v175, v171, s63
  v_mfma_f32_16x16x32_bf16 a[52:55], a[184:187], v[24:27], a[52:55]
  v_perm_b32 v34, v183, v179, s63
  v_perm_b32 v35, v191, v187, s63
  v_mfma_f32_16x16x32_bf16 a[84:87], a[188:191], v[24:27], a[84:87]
  v_mfma_f32_16x16x32_bf16 a[116:119], a[192:195], v[24:27], a[116:119]
  global_load_dwordx4 v[132:135], v3, s[6:7] offset:512
  v_mfma_f32_16x16x32_bf16 a[148:151], a[196:199], v[24:27], a[148:151]
  v_mfma_f32_16x16x32_bf16 a[24:27], a[180:183], v[28:31], a[24:27]
  s_waitcnt vmcnt(30)
  v_perm_b32 v20, v196, v192, s62
  v_mfma_f32_16x16x32_bf16 a[56:59], a[184:187], v[28:31], a[56:59]
  v_perm_b32 v21, v204, v200, s62
  v_perm_b32 v22, v212, v208, s62
  v_mfma_f32_16x16x32_bf16 a[88:91], a[188:191], v[28:31], a[88:91]
  v_perm_b32 v23, v220, v216, s62
  v_mfma_f32_16x16x32_bf16 a[120:123], a[192:195], v[28:31], a[120:123]
  v_mfma_f32_16x16x32_bf16 a[152:155], a[196:199], v[28:31], a[152:155]
  global_load_dwordx4 v[136:139], v3, s[6:7] offset:1024
  v_mfma_f32_16x16x32_bf16 a[28:31], a[180:183], v[32:35], a[28:31]
  v_perm_b32 v24, v196, v192, s63
  v_perm_b32 v25, v204, v200, s63
  v_mfma_f32_16x16x32_bf16 a[60:63], a[184:187], v[32:35], a[60:63]
  v_perm_b32 v26, v212, v208, s63
  v_perm_b32 v27, v220, v216, s63
  v_mfma_f32_16x16x32_bf16 a[92:95], a[188:191], v[32:35], a[92:95]
  v_mfma_f32_16x16x32_bf16 a[124:127], a[192:195], v[32:35], a[124:127]
  v_mfma_f32_16x16x32_bf16 a[156:159], a[196:199], v[32:35], a[156:159]
  s_waitcnt lgkmcnt(0)
  v_mfma_f32_16x16x32_bf16 a[0:3], a[160:163], v[20:23], a[0:3]
  global_load_dwordx4 v[140:143], v3, s[6:7] offset:1536
  v_perm_b32 v28, v197, v193, s62
  v_perm_b32 v29, v205, v201, s62
  v_mfma_f32_16x16x32_bf16 a[32:35], a[164:167], v[20:23], a[32:35]
  v_perm_b32 v30, v213, v209, s62
  v_perm_b32 v31, v221, v217, s62
  v_mfma_f32_16x16x32_bf16 a[64:67], a[168:171], v[20:23], a[64:67]
  ds_read_b128 a[180:183], v15 offset:0
  v_mfma_f32_16x16x32_bf16 a[96:99], a[172:175], v[20:23], a[96:99]
  v_mfma_f32_16x16x32_bf16 a[128:131], a[176:179], v[20:23], a[128:131]
  v_mfma_f32_16x16x32_bf16 a[4:7], a[160:163], v[24:27], a[4:7]
  v_perm_b32 v32, v197, v193, s63
  global_load_dwordx4 v[144:147], v3, s[6:7] offset:2048
  v_perm_b32 v33, v205, v201, s63
  v_mfma_f32_16x16x32_bf16 a[36:39], a[164:167], v[24:27], a[36:39]
  v_perm_b32 v34, v213, v209, s63
  v_perm_b32 v35, v221, v217, s63
  v_mfma_f32_16x16x32_bf16 a[68:71], a[168:171], v[24:27], a[68:71]
  ds_read_b128 a[184:187], v15 offset:4608
  v_mfma_f32_16x16x32_bf16 a[100:103], a[172:175], v[24:27], a[100:103]
  v_mfma_f32_16x16x32_bf16 a[132:135], a[176:179], v[24:27], a[132:135]
  v_mfma_f32_16x16x32_bf16 a[8:11], a[160:163], v[28:31], a[8:11]
  v_perm_b32 v20, v198, v194, s62
  v_perm_b32 v21, v206, v202, s62
  global_load_dwordx4 v[148:151], v3, s[6:7] offset:2560
  v_mfma_f32_16x16x32_bf16 a[40:43], a[164:167], v[28:31], a[40:43]
  v_perm_b32 v22, v214, v210, s62
  v_perm_b32 v23, v222, v218, s62
  v_mfma_f32_16x16x32_bf16 a[72:75], a[168:171], v[28:31], a[72:75]
  ds_read_b128 a[188:191], v16 offset:0
  v_mfma_f32_16x16x32_bf16 a[104:107], a[172:175], v[28:31], a[104:107]
  v_mfma_f32_16x16x32_bf16 a[136:139], a[176:179], v[28:31], a[136:139]
  v_mfma_f32_16x16x32_bf16 a[12:15], a[160:163], v[32:35], a[12:15]
  v_perm_b32 v24, v198, v194, s63
  v_perm_b32 v25, v206, v202, s63
  v_mfma_f32_16x16x32_bf16 a[44:47], a[164:167], v[32:35], a[44:47]
  global_load_dwordx4 v[152:155], v3, s[6:7] offset:3072
  v_perm_b32 v26, v214, v210, s63
  v_perm_b32 v27, v222, v218, s63
  v_mfma_f32_16x16x32_bf16 a[76:79], a[168:171], v[32:35], a[76:79]
  ds_read_b128 a[192:195], v16 offset:4608
  v_mfma_f32_16x16x32_bf16 a[108:111], a[172:175], v[32:35], a[108:111]
  v_mfma_f32_16x16x32_bf16 a[140:143], a[176:179], v[32:35], a[140:143]
  v_mfma_f32_16x16x32_bf16 a[16:19], a[160:163], v[20:23], a[16:19]
  v_perm_b32 v28, v199, v195, s62
  v_perm_b32 v29, v207, v203, s62
  v_mfma_f32_16x16x32_bf16 a[48:51], a[164:167], v[20:23], a[48:51]
  v_perm_b32 v30, v215, v211, s62
  global_load_dwordx4 v[156:159], v3, s[6:7] offset:3584
  v_perm_b32 v31, v223, v219, s62
  v_mfma_f32_16x16x32_bf16 a[80:83], a[168:171], v[20:23], a[80:83]
  ds_read_b128 a[196:199], v17 offset:0
  v_mfma_f32_16x16x32_bf16 a[112:115], a[172:175], v[20:23], a[112:115]
  v_mfma_f32_16x16x32_bf16 a[144:147], a[176:179], v[20:23], a[144:147]
  v_mfma_f32_16x16x32_bf16 a[20:23], a[160:163], v[24:27], a[20:23]
  v_perm_b32 v32, v199, v195, s63
  v_perm_b32 v33, v207, v203, s63
  v_mfma_f32_16x16x32_bf16 a[52:55], a[164:167], v[24:27], a[52:55]
  v_perm_b32 v34, v215, v211, s63
  v_perm_b32 v35, v223, v219, s63
  v_add_u32 v3, 0x18000, v1
  global_load_dwordx4 v[160:163], v3, s[6:7] offset:0
  v_mfma_f32_16x16x32_bf16 a[84:87], a[168:171], v[24:27], a[84:87]
  v_mfma_f32_16x16x32_bf16 a[116:119], a[172:175], v[24:27], a[116:119]
  v_mfma_f32_16x16x32_bf16 a[148:151], a[176:179], v[24:27], a[148:151]
  v_mfma_f32_16x16x32_bf16 a[24:27], a[160:163], v[28:31], a[24:27]
  s_waitcnt vmcnt(29)
  v_perm_b32 v20, v228, v224, s62
  v_mfma_f32_16x16x32_bf16 a[56:59], a[164:167], v[28:31], a[56:59]
  v_perm_b32 v21, v236, v232, s62
  v_perm_b32 v22, v244, v240, s62
  v_mfma_f32_16x16x32_bf16 a[88:91], a[168:171], v[28:31], a[88:91]
  global_load_dwordx4 v[164:167], v3, s[6:7] offset:512
  v_perm_b32 v23, v252, v248, s62
  v_mfma_f32_16x16x32_bf16 a[120:123], a[172:175], v[28:31], a[120:123]
  v_mfma_f32_16x16x32_bf16 a[152:155], a[176:179], v[28:31], a[152:155]
  v_mfma_f32_16x16x32_bf16 a[28:31], a[160:163], v[32:35], a[28:31]
  v_perm_b32 v24, v228, v224, s63
  v_perm_b32 v25, v236, v232, s63
  v_mfma_f32_16x16x32_bf16 a[60:63], a[164:167], v[32:35], a[60:63]
  v_perm_b32 v26, v244, v240, s63
  v_perm_b32 v27, v252, v248, s63
  v_mfma_f32_16x16x32_bf16 a[92:95], a[168:171], v[32:35], a[92:95]
  v_mfma_f32_16x16x32_bf16 a[124:127], a[172:175], v[32:35], a[124:127]
  global_load_dwordx4 v[168:171], v3, s[6:7] offset:1024
  v_mfma_f32_16x16x32_bf16 a[156:159], a[176:179], v[32:35], a[156:159]
  s_waitcnt vmcnt(47)
  s_barrier
  v_add_u32 v4, 0x4c80, v4
  global_load_dwordx4 v[172:175], v3, s[6:7] offset:1536
  v_add_u32 v5, 0x4c80, v5
  v_add_u32 v6, 0x4c80, v6
  s_waitcnt lgkmcnt(0)
  v_mfma_f32_16x16x32_bf16 a[0:3], a[180:183], v[20:23], a[0:3]
  v_perm_b32 v28, v229, v225, s62
  v_perm_b32 v29, v237, v233, s62
  v_mfma_f32_16x16x32_bf16 a[32:35], a[184:187], v[20:23], a[32:35]
  v_perm_b32 v30, v245, v241, s62
  v_perm_b32 v31, v253, v249, s62
  v_mfma_f32_16x16x32_bf16 a[64:67], a[188:191], v[20:23], a[64:67]
  ds_read_b128 a[160:163], v4 offset:0
  v_mfma_f32_16x16x32_bf16 a[96:99], a[192:195], v[20:23], a[96:99]
  v_mfma_f32_16x16x32_bf16 a[128:131], a[196:199], v[20:23], a[128:131]
  global_load_dwordx4 v[176:179], v3, s[6:7] offset:2048
  v_mfma_f32_16x16x32_bf16 a[4:7], a[180:183], v[24:27], a[4:7]
  v_perm_b32 v32, v229, v225, s63
  v_perm_b32 v33, v237, v233, s63
  v_mfma_f32_16x16x32_bf16 a[36:39], a[184:187], v[24:27], a[36:39]
  v_perm_b32 v34, v245, v241, s63
  v_perm_b32 v35, v253, v249, s63
  v_mfma_f32_16x16x32_bf16 a[68:71], a[188:191], v[24:27], a[68:71]
  ds_read_b128 a[164:167], v4 offset:4608
  v_mfma_f32_16x16x32_bf16 a[100:103], a[192:195], v[24:27], a[100:103]
  v_mfma_f32_16x16x32_bf16 a[132:135], a[196:199], v[24:27], a[132:135]
  v_mfma_f32_16x16x32_bf16 a[8:11], a[180:183], v[28:31], a[8:11]
  global_load_dwordx4 v[180:183], v3, s[6:7] offset:2560
  v_perm_b32 v20, v230, v226, s62
  v_perm_b32 v21, v238, v234, s62
  v_mfma_f32_16x16x32_bf16 a[40:43], a[184:187], v[28:31], a[40:43]
  v_perm_b32 v22, v246, v242, s62
  v_perm_b32 v23, v254, v250, s62
  v_mfma_f32_16x16x32_bf16 a[72:75], a[188:191], v[28:31], a[72:75]
  ds_read_b128 a[168:171], v5 offset:0
  v_mfma_f32_16x16x32_bf16 a[104:107], a[192:195], v[28:31], a[104:107]
  v_mfma_f32_16x16x32_bf16 a[136:139], a[196:199], v[28:31], a[136:139]
  v_mfma_f32_16x16x32_bf16 a[12:15], a[180:183], v[32:35], a[12:15]
  v_perm_b32 v24, v230, v226, s63
  global_load_dwordx4 v[184:187], v3, s[6:7] offset:3072
  v_perm_b32 v25, v238, v234, s63
  v_mfma_f32_16x16x32_bf16 a[44:47], a[184:187], v[32:35], a[44:47]
  v_perm_b32 v26, v246, v242, s63
  v_perm_b32 v27, v254, v250, s63
  v_mfma_f32_16x16x32_bf16 a[76:79], a[188:191], v[32:35], a[76:79]
  ds_read_b128 a[172:175], v5 offset:4608
  v_mfma_f32_16x16x32_bf16 a[108:111], a[192:195], v[32:35], a[108:111]
  v_mfma_f32_16x16x32_bf16 a[140:143], a[196:199], v[32:35], a[140:143]
  v_mfma_f32_16x16x32_bf16 a[16:19], a[180:183], v[20:23], a[16:19]
  v_perm_b32 v28, v231, v227, s62
  v_perm_b32 v29, v239, v235, s62
  global_load_dwordx4 v[188:191], v3, s[6:7] offset:3584
  v_mfma_f32_16x16x32_bf16 a[48:51], a[184:187], v[20:23], a[48:51]
  v_perm_b32 v30, v247, v243, s62
  v_perm_b32 v31, v255, v251, s62
  v_mfma_f32_16x16x32_bf16 a[80:83], a[188:191], v[20:23], a[80:83]
  ds_read_b128 a[176:179], v6 offset:0
  v_mfma_f32_16x16x32_bf16 a[112:115], a[192:195], v[20:23], a[112:115]
  v_mfma_f32_16x16x32_bf16 a[144:147], a[196:199], v[20:23], a[144:147]
  v_mfma_f32_16x16x32_bf16 a[20:23], a[180:183], v[24:27], a[20:23]
  v_perm_b32 v32, v231, v227, s63
  v_perm_b32 v33, v239, v235, s63
  v_mfma_f32_16x16x32_bf16 a[52:55], a[184:187], v[24:27], a[52:55]
  v_add_u32 v3, 0x38000, v1
  global_load_dwordx4 v[192:195], v3, s[6:7] offset:0
  v_perm_b32 v34, v247, v243, s63
  v_perm_b32 v35, v255, v251, s63
  v_mfma_f32_16x16x32_bf16 a[84:87], a[188:191], v[24:27], a[84:87]
  v_mfma_f32_16x16x32_bf16 a[116:119], a[192:195], v[24:27], a[116:119]
  v_mfma_f32_16x16x32_bf16 a[148:151], a[196:199], v[24:27], a[148:151]
  v_mfma_f32_16x16x32_bf16 a[24:27], a[180:183], v[28:31], a[24:27]
  s_waitcnt vmcnt(25)
  v_perm_b32 v20, v68, v64, s62
  v_mfma_f32_16x16x32_bf16 a[56:59], a[184:187], v[28:31], a[56:59]
  v_perm_b32 v21, v76, v72, s62
  v_perm_b32 v22, v84, v80, s62
  v_mfma_f32_16x16x32_bf16 a[88:91], a[188:191], v[28:31], a[88:91]
  global_load_dwordx4 v[196:199], v3, s[6:7] offset:512
  v_perm_b32 v23, v92, v88, s62
  v_mfma_f32_16x16x32_bf16 a[120:123], a[192:195], v[28:31], a[120:123]
  v_mfma_f32_16x16x32_bf16 a[152:155], a[196:199], v[28:31], a[152:155]
  v_mfma_f32_16x16x32_bf16 a[28:31], a[180:183], v[32:35], a[28:31]
  v_perm_b32 v24, v68, v64, s63
  v_perm_b32 v25, v76, v72, s63
  v_mfma_f32_16x16x32_bf16 a[60:63], a[184:187], v[32:35], a[60:63]
  v_perm_b32 v26, v84, v80, s63
  v_perm_b32 v27, v92, v88, s63
  v_mfma_f32_16x16x32_bf16 a[92:95], a[188:191], v[32:35], a[92:95]
  v_mfma_f32_16x16x32_bf16 a[124:127], a[192:195], v[32:35], a[124:127]
  global_load_dwordx4 v[200:203], v3, s[6:7] offset:1024
  v_mfma_f32_16x16x32_bf16 a[156:159], a[196:199], v[32:35], a[156:159]
  v_add_u32 v15, 0x4c80, v15
  v_add_u32 v16, 0x4c80, v16
  v_add_u32 v17, 0x4c80, v17
  v_and_b32 v41, 15, v14
  v_lshlrev_b32 v41, 2, v41
  global_load_dword v0, v41, s[84:85] offset:64 sc0 sc1
  global_load_dwordx4 v[204:207], v3, s[6:7] offset:1536
  s_waitcnt lgkmcnt(0)
  v_mfma_f32_16x16x32_bf16 a[0:3], a[160:163], v[20:23], a[0:3]
  v_perm_b32 v28, v69, v65, s62
  v_perm_b32 v29, v77, v73, s62
  v_mfma_f32_16x16x32_bf16 a[32:35], a[164:167], v[20:23], a[32:35]
  v_perm_b32 v30, v85, v81, s62
  v_perm_b32 v31, v93, v89, s62
  v_mfma_f32_16x16x32_bf16 a[64:67], a[168:171], v[20:23], a[64:67]
  ds_read_b128 a[180:183], v4 offset:128
  v_mfma_f32_16x16x32_bf16 a[96:99], a[172:175], v[20:23], a[96:99]
  v_mfma_f32_16x16x32_bf16 a[128:131], a[176:179], v[20:23], a[128:131]
  global_load_dwordx4 v[208:211], v3, s[6:7] offset:2048
  v_mfma_f32_16x16x32_bf16 a[4:7], a[160:163], v[24:27], a[4:7]
  v_perm_b32 v32, v69, v65, s63
  v_perm_b32 v33, v77, v73, s63
  v_mfma_f32_16x16x32_bf16 a[36:39], a[164:167], v[24:27], a[36:39]
  v_perm_b32 v34, v85, v81, s63
  v_perm_b32 v35, v93, v89, s63
  v_mfma_f32_16x16x32_bf16 a[68:71], a[168:171], v[24:27], a[68:71]
  ds_read_b128 a[184:187], v4 offset:4736
  v_mfma_f32_16x16x32_bf16 a[100:103], a[172:175], v[24:27], a[100:103]
  v_mfma_f32_16x16x32_bf16 a[132:135], a[176:179], v[24:27], a[132:135]
  v_mfma_f32_16x16x32_bf16 a[8:11], a[160:163], v[28:31], a[8:11]
  global_load_dwordx4 v[212:215], v3, s[6:7] offset:2560
  v_perm_b32 v20, v70, v66, s62
  v_perm_b32 v21, v78, v74, s62
  v_mfma_f32_16x16x32_bf16 a[40:43], a[164:167], v[28:31], a[40:43]
  v_perm_b32 v22, v86, v82, s62
  v_perm_b32 v23, v94, v90, s62
  v_mfma_f32_16x16x32_bf16 a[72:75], a[168:171], v[28:31], a[72:75]
  ds_read_b128 a[188:191], v5 offset:128
  v_mfma_f32_16x16x32_bf16 a[104:107], a[172:175], v[28:31], a[104:107]
  v_mfma_f32_16x16x32_bf16 a[136:139], a[176:179], v[28:31], a[136:139]
  v_mfma_f32_16x16x32_bf16 a[12:15], a[160:163], v[32:35], a[12:15]
  v_perm_b32 v24, v70, v66, s63
  global_load_dwordx4 v[216:219], v3, s[6:7] offset:3072
  v_perm_b32 v25, v78, v74, s63
  v_mfma_f32_16x16x32_bf16 a[44:47], a[164:167], v[32:35], a[44:47]
  v_perm_b32 v26, v86, v82, s63
  v_perm_b32 v27, v94, v90, s63
  v_mfma_f32_16x16x32_bf16 a[76:79], a[168:171], v[32:35], a[76:79]
  ds_read_b128 a[192:195], v5 offset:4736
  v_mfma_f32_16x16x32_bf16 a[108:111], a[172:175], v[32:35], a[108:111]
  v_mfma_f32_16x16x32_bf16 a[140:143], a[176:179], v[32:35], a[140:143]
  v_mfma_f32_16x16x32_bf16 a[16:19], a[160:163], v[20:23], a[16:19]
  v_perm_b32 v28, v71, v67, s62
  v_perm_b32 v29, v79, v75, s62
  global_load_dwordx4 v[220:223], v3, s[6:7] offset:3584
  v_mfma_f32_16x16x32_bf16 a[48:51], a[164:167], v[20:23], a[48:51]
  v_perm_b32 v30, v87, v83, s62
  v_perm_b32 v31, v95, v91, s62
  v_mfma_f32_16x16x32_bf16 a[80:83], a[168:171], v[20:23], a[80:83]
  ds_read_b128 a[196:199], v6 offset:128
  v_mfma_f32_16x16x32_bf16 a[112:115], a[172:175], v[20:23], a[112:115]
  v_mfma_f32_16x16x32_bf16 a[144:147], a[176:179], v[20:23], a[144:147]
  v_mfma_f32_16x16x32_bf16 a[20:23], a[160:163], v[24:27], a[20:23]
  v_perm_b32 v32, v71, v67, s63
  v_perm_b32 v33, v79, v75, s63
  v_mfma_f32_16x16x32_bf16 a[52:55], a[164:167], v[24:27], a[52:55]
  v_add_u32 v3, 0x58000, v1
  global_load_dwordx4 v[224:227], v3, s[6:7] offset:0
  v_perm_b32 v34, v87, v83, s63
  v_perm_b32 v35, v95, v91, s63
  v_mfma_f32_16x16x32_bf16 a[84:87], a[168:171], v[24:27], a[84:87]
  v_mfma_f32_16x16x32_bf16 a[116:119], a[172:175], v[24:27], a[116:119]
  v_mfma_f32_16x16x32_bf16 a[148:151], a[176:179], v[24:27], a[148:151]
  v_mfma_f32_16x16x32_bf16 a[24:27], a[160:163], v[28:31], a[24:27]
  s_waitcnt vmcnt(26)
  v_perm_b32 v20, v100, v96, s62
  v_mfma_f32_16x16x32_bf16 a[56:59], a[164:167], v[28:31], a[56:59]
  v_perm_b32 v21, v108, v104, s62
  v_perm_b32 v22, v116, v112, s62
  v_mfma_f32_16x16x32_bf16 a[88:91], a[168:171], v[28:31], a[88:91]
  global_load_dwordx4 v[228:231], v3, s[6:7] offset:512
  v_perm_b32 v23, v124, v120, s62
  v_mfma_f32_16x16x32_bf16 a[120:123], a[172:175], v[28:31], a[120:123]
  v_mfma_f32_16x16x32_bf16 a[152:155], a[176:179], v[28:31], a[152:155]
  v_mfma_f32_16x16x32_bf16 a[28:31], a[160:163], v[32:35], a[28:31]
  v_perm_b32 v24, v100, v96, s63
  v_perm_b32 v25, v108, v104, s63
  v_mfma_f32_16x16x32_bf16 a[60:63], a[164:167], v[32:35], a[60:63]
  v_perm_b32 v26, v116, v112, s63
  v_perm_b32 v27, v124, v120, s63
  v_mfma_f32_16x16x32_bf16 a[92:95], a[168:171], v[32:35], a[92:95]
  v_mfma_f32_16x16x32_bf16 a[124:127], a[172:175], v[32:35], a[124:127]
  global_load_dwordx4 v[232:235], v3, s[6:7] offset:1024
  v_mfma_f32_16x16x32_bf16 a[156:159], a[176:179], v[32:35], a[156:159]
  s_waitcnt lgkmcnt(0)
  v_mfma_f32_16x16x32_bf16 a[0:3], a[180:183], v[20:23], a[0:3]
  v_perm_b32 v28, v101, v97, s62
  v_perm_b32 v29, v109, v105, s62
  v_mfma_f32_16x16x32_bf16 a[32:35], a[184:187], v[20:23], a[32:35]
  v_perm_b32 v30, v117, v113, s62
  v_perm_b32 v31, v125, v121, s62
  v_mfma_f32_16x16x32_bf16 a[64:67], a[188:191], v[20:23], a[64:67]
  ds_read_b128 a[160:163], v15 offset:0
  v_mfma_f32_16x16x32_bf16 a[96:99], a[192:195], v[20:23], a[96:99]
  global_load_dwordx4 v[236:239], v3, s[6:7] offset:1536
  v_mfma_f32_16x16x32_bf16 a[128:131], a[196:199], v[20:23], a[128:131]
  v_mfma_f32_16x16x32_bf16 a[4:7], a[180:183], v[24:27], a[4:7]
  v_perm_b32 v32, v101, v97, s63
  v_perm_b32 v33, v109, v105, s63
  v_mfma_f32_16x16x32_bf16 a[36:39], a[184:187], v[24:27], a[36:39]
  v_perm_b32 v34, v117, v113, s63
  v_perm_b32 v35, v125, v121, s63
  v_mfma_f32_16x16x32_bf16 a[68:71], a[188:191], v[24:27], a[68:71]
  ds_read_b128 a[164:167], v15 offset:4608
  v_mfma_f32_16x16x32_bf16 a[100:103], a[192:195], v[24:27], a[100:103]
  v_mfma_f32_16x16x32_bf16 a[132:135], a[196:199], v[24:27], a[132:135]
  global_load_dwordx4 v[240:243], v3, s[6:7] offset:2048
  v_mfma_f32_16x16x32_bf16 a[8:11], a[180:183], v[28:31], a[8:11]
  v_perm_b32 v20, v102, v98, s62
  v_perm_b32 v21, v110, v106, s62
  v_mfma_f32_16x16x32_bf16 a[40:43], a[184:187], v[28:31], a[40:43]
  v_perm_b32 v22, v118, v114, s62
  v_perm_b32 v23, v126, v122, s62
  v_mfma_f32_16x16x32_bf16 a[72:75], a[188:191], v[28:31], a[72:75]
  ds_read_b128 a[168:171], v16 offset:0
  v_mfma_f32_16x16x32_bf16 a[104:107], a[192:195], v[28:31], a[104:107]
  v_mfma_f32_16x16x32_bf16 a[136:139], a[196:199], v[28:31], a[136:139]
  v_mfma_f32_16x16x32_bf16 a[12:15], a[180:183], v[32:35], a[12:15]
  global_load_dwordx4 v[244:247], v3, s[6:7] offset:2560
  v_perm_b32 v24, v102, v98, s63
  v_perm_b32 v25, v110, v106, s63
  v_mfma_f32_16x16x32_bf16 a[44:47], a[184:187], v[32:35], a[44:47]
  v_perm_b32 v26, v118, v114, s63
  v_perm_b32 v27, v126, v122, s63
  v_mfma_f32_16x16x32_bf16 a[76:79], a[188:191], v[32:35], a[76:79]
  ds_read_b128 a[172:175], v16 offset:4608
  v_mfma_f32_16x16x32_bf16 a[108:111], a[192:195], v[32:35], a[108:111]
  v_mfma_f32_16x16x32_bf16 a[140:143], a[196:199], v[32:35], a[140:143]
  v_mfma_f32_16x16x32_bf16 a[16:19], a[180:183], v[20:23], a[16:19]
  v_perm_b32 v28, v103, v99, s62
  global_load_dwordx4 v[248:251], v3, s[6:7] offset:3072
  v_perm_b32 v29, v111, v107, s62
  v_mfma_f32_16x16x32_bf16 a[48:51], a[184:187], v[20:23], a[48:51]
  v_perm_b32 v30, v119, v115, s62
  v_perm_b32 v31, v127, v123, s62
  v_mfma_f32_16x16x32_bf16 a[80:83], a[188:191], v[20:23], a[80:83]
  ds_read_b128 a[176:179], v17 offset:0
  v_mfma_f32_16x16x32_bf16 a[112:115], a[192:195], v[20:23], a[112:115]
  v_mfma_f32_16x16x32_bf16 a[144:147], a[196:199], v[20:23], a[144:147]
  v_mfma_f32_16x16x32_bf16 a[20:23], a[180:183], v[24:27], a[20:23]
  v_perm_b32 v32, v103, v99, s63
  v_perm_b32 v33, v111, v107, s63
  global_load_dwordx4 v[252:255], v3, s[6:7] offset:3584
  v_mfma_f32_16x16x32_bf16 a[52:55], a[184:187], v[24:27], a[52:55]
  v_perm_b32 v34, v119, v115, s63
  v_perm_b32 v35, v127, v123, s63
  v_mfma_f32_16x16x32_bf16 a[84:87], a[188:191], v[24:27], a[84:87]
  v_mfma_f32_16x16x32_bf16 a[116:119], a[192:195], v[24:27], a[116:119]
  v_mfma_f32_16x16x32_bf16 a[148:151], a[196:199], v[24:27], a[148:151]
  v_mfma_f32_16x16x32_bf16 a[24:27], a[180:183], v[28:31], a[24:27]
  s_waitcnt vmcnt(25)
  v_perm_b32 v20, v132, v128, s62
  v_mfma_f32_16x16x32_bf16 a[56:59], a[184:187], v[28:31], a[56:59]
  v_perm_b32 v21, v140, v136, s62
  v_perm_b32 v22, v148, v144, s62
  v_mfma_f32_16x16x32_bf16 a[88:91], a[188:191], v[28:31], a[88:91]
  v_perm_b32 v23, v156, v152, s62
  v_mfma_f32_16x16x32_bf16 a[120:123], a[192:195], v[28:31], a[120:123]
  v_mfma_f32_16x16x32_bf16 a[152:155], a[196:199], v[28:31], a[152:155]
  v_mfma_f32_16x16x32_bf16 a[28:31], a[180:183], v[32:35], a[28:31]
  v_perm_b32 v24, v132, v128, s63
  v_perm_b32 v25, v140, v136, s63
  v_mfma_f32_16x16x32_bf16 a[60:63], a[184:187], v[32:35], a[60:63]
  v_perm_b32 v26, v148, v144, s63
  v_perm_b32 v27, v156, v152, s63
  v_mfma_f32_16x16x32_bf16 a[92:95], a[188:191], v[32:35], a[92:95]
  v_mfma_f32_16x16x32_bf16 a[124:127], a[192:195], v[32:35], a[124:127]
  v_mfma_f32_16x16x32_bf16 a[156:159], a[196:199], v[32:35], a[156:159]
  s_waitcnt vmcnt(49)
  s_barrier
  v_add_u32 v4, 0x4c80, v4
  v_add_u32 v5, 0x4c80, v5
  v_add_u32 v6, 0x4c80, v6
  s_waitcnt vmcnt(13)
L_wf_chk:
  v_cmp_eq_u32 vcc, 0, v0
  s_nop 1
  s_cmp_eq_u64 vcc, 0
  s_cbranch_scc1 L_wf_ok
  s_sleep 12
  global_load_dword v0, v41, s[84:85] offset:64 sc0 sc1
  s_waitcnt vmcnt(0)
  s_branch L_wf_chk
L_wf_ok:
  s_lshr_b32 s94, s2, 3
  s_and_b32 s94, s94, 31
  s_lshl_b32 s94, s94, 2
  s_add_u32 s94, s94, s56
  s_mul_i32 s95, s94, 3072
  s_add_u32 s95, s95, 65536
  v_lshlrev_b32 v41, 4, v14
  v_add_u32 v41, s95, v41
  global_load_dwordx4 a[252:255], v41, s[80:81] offset:0 sc1
  s_waitcnt lgkmcnt(0)
  v_mfma_f32_16x16x32_bf16 a[0:3], a[160:163], v[20:23], a[0:3]
  v_perm_b32 v28, v133, v129, s62
  v_perm_b32 v29, v141, v137, s62
  v_mfma_f32_16x16x32_bf16 a[32:35], a[164:167], v[20:23], a[32:35]
  v_perm_b32 v30, v149, v145, s62
  v_perm_b32 v31, v157, v153, s62
  v_mfma_f32_16x16x32_bf16 a[64:67], a[168:171], v[20:23], a[64:67]
  ds_read_b128 a[180:183], v4 offset:0
  v_mfma_f32_16x16x32_bf16 a[96:99], a[172:175], v[20:23], a[96:99]
  v_mfma_f32_16x16x32_bf16 a[128:131], a[176:179], v[20:23], a[128:131]
  global_load_dwordx4 a[252:255], v41, s[80:81] offset:1024 sc1
  v_mfma_f32_16x16x32_bf16 a[4:7], a[160:163], v[24:27], a[4:7]
  v_perm_b32 v32, v133, v129, s63
  v_perm_b32 v33, v141, v137, s63
  v_mfma_f32_16x16x32_bf16 a[36:39], a[164:167], v[24:27], a[36:39]
  v_perm_b32 v34, v149, v145, s63
  v_perm_b32 v35, v157, v153, s63
  v_mfma_f32_16x16x32_bf16 a[68:71], a[168:171], v[24:27], a[68:71]
  ds_read_b128 a[184:187], v4 offset:4608
  v_mfma_f32_16x16x32_bf16 a[100:103], a[172:175], v[24:27], a[100:103]
  v_mfma_f32_16x16x32_bf16 a[132:135], a[176:179], v[24:27], a[132:135]
  v_mfma_f32_16x16x32_bf16 a[8:11], a[160:163], v[28:31], a[8:11]
  global_load_dwordx4 a[252:255], v41, s[80:81] offset:2048 sc1
  v_perm_b32 v20, v134, v130, s62
  v_perm_b32 v21, v142, v138, s62
  v_mfma_f32_16x16x32_bf16 a[40:43], a[164:167], v[28:31], a[40:43]
  v_perm_b32 v22, v150, v146, s62
  v_perm_b32 v23, v158, v154, s62
  v_mfma_f32_16x16x32_bf16 a[72:75], a[168:171], v[28:31], a[72:75]
  ds_read_b128 a[188:191], v5 offset:0
  v_mfma_f32_16x16x32_bf16 a[104:107], a[172:175], v[28:31], a[104:107]
  v_mfma_f32_16x16x32_bf16 a[136:139], a[176:179], v[28:31], a[136:139]
  v_mfma_f32_16x16x32_bf16 a[12:15], a[160:163], v[32:35], a[12:15]
  v_perm_b32 v24, v134, v130, s63
  v_add_u32 v3, 0x10000, v2
  global_load_dwordx4 a[200:203], v3, s[80:81] offset:0 sc1
  v_perm_b32 v25, v142, v138, s63
  v_mfma_f32_16x16x32_bf16 a[44:47], a[164:167], v[32:35], a[44:47]
  v_perm_b32 v26, v150, v146, s63
  v_perm_b32 v27, v158, v154, s63
  v_mfma_f32_16x16x32_bf16 a[76:79], a[168:171], v[32:35], a[76:79]
  ds_read_b128 a[192:195], v5 offset:4608
  v_mfma_f32_16x16x32_bf16 a[108:111], a[172:175], v[32:35], a[108:111]
  v_mfma_f32_16x16x32_bf16 a[140:143], a[176:179], v[32:35], a[140:143]
  v_mfma_f32_16x16x32_bf16 a[16:19], a[160:163], v[20:23], a[16:19]
  v_perm_b32 v28, v135, v131, s62
  v_perm_b32 v29, v143, v139, s62
  global_load_dwordx4 a[204:207], v3, s[80:81] offset:1024 sc1
  v_mfma_f32_16x16x32_bf16 a[48:51], a[164:167], v[20:23], a[48:51]
  v_perm_b32 v30, v151, v147, s62
  v_perm_b32 v31, v159, v155, s62
  v_mfma_f32_16x16x32_bf16 a[80:83], a[168:171], v[20:23], a[80:83]
  ds_read_b128 a[196:199], v6 offset:0
  v_mfma_f32_16x16x32_bf16 a[112:115], a[172:175], v[20:23], a[112:115]
  v_mfma_f32_16x16x32_bf16 a[144:147], a[176:179], v[20:23], a[144:147]
  v_mfma_f32_16x16x32_bf16 a[20:23], a[160:163], v[24:27], a[20:23]
  v_perm_b32 v32, v135, v131, s63
  v_perm_b32 v33, v143, v139, s63
  v_mfma_f32_16x16x32_bf16 a[52:55], a[164:167], v[24:27], a[52:55]
  global_load_dwordx4 a[208:211], v3, s[80:81] offset:2048 sc1
  v_perm_b32 v34, v151, v147, s63
  v_perm_b32 v35, v159, v155, s63
  v_mfma_f32_16x16x32_bf16 a[84:87], a[168:171], v[24:27], a[84:87]
  v_mfma_f32_16x16x32_bf16 a[116:119], a[172:175], v[24:27], a[116:119]
  v_mfma_f32_16x16x32_bf16 a[148:151], a[176:179], v[24:27], a[148:151]
  v_mfma_f32_16x16x32_bf16 a[24:27], a[160:163], v[28:31], a[24:27]
  s_waitcnt vmcnt(23)
  v_perm_b32 v20, v164, v160, s62
  v_mfma_f32_16x16x32_bf16 a[56:59], a[164:167], v[28:31], a[56:59]
  v_perm_b32 v21, v172, v168, s62
  v_perm_b32 v22, v180, v176, s62
  v_mfma_f32_16x16x32_bf16 a[88:91], a[168:171], v[28:31], a[88:91]
  global_load_dwordx4 a[212:215], v3, s[80:81] offset:3072 sc1
  v_perm_b32 v23, v188, v184, s62
  v_mfma_f32_16x16x32_bf16 a[120:123], a[172:175], v[28:31], a[120:123]
  v_mfma_f32_16x16x32_bf16 a[152:155], a[176:179], v[28:31], a[152:155]
  v_mfma_f32_16x16x32_bf16 a[28:31], a[160:163], v[32:35], a[28:31]
  v_perm_b32 v24, v164, v160, s63
  v_perm_b32 v25, v172, v168, s63
  v_mfma_f32_16x16x32_bf16 a[60:63], a[164:167], v[32:35], a[60:63]
  v_perm_b32 v26, v180, v176, s63
  v_perm_b32 v27, v188, v184, s63
  v_mfma_f32_16x16x32_bf16 a[92:95], a[168:171], v[32:35], a[92:95]
  v_mfma_f32_16x16x32_bf16 a[124:127], a[172:175], v[32:35], a[124:127]
  v_add_u32 v3, 0x14000, v2
  global_load_dwordx4 a[216:219], v3, s[80:81] offset:0 sc1
  v_mfma_f32_16x16x32_bf16 a[156:159], a[176:179], v[32:35], a[156:159]
  v_add_u32 v15, 0x4c80, v15
  v_add_u32 v16, 0x4c80, v16
  v_add_u32 v17, 0x4c80, v17
  s_waitcnt lgkmcnt(0)
  v_mfma_f32_16x16x32_bf16 a[0:3], a[180:183], v[20:23], a[0:3]
  v_perm_b32 v28, v165, v161, s62
  v_perm_b32 v29, v173, v169, s62
  v_mfma_f32_16x16x32_bf16 a[32:35], a[184:187], v[20:23], a[32:35]
  v_perm_b32 v30, v181, v177, s62
  v_perm_b32 v31, v189, v185, s62
  v_mfma_f32_16x16x32_bf16 a[64:67], a[188:191], v[20:23], a[64:67]
  ds_read_b128 a[160:163], v4 offset:128
  global_load_dwordx4 a[220:223], v3, s[80:81] offset:1024 sc1
  v_mfma_f32_16x16x32_bf16 a[96:99], a[192:195], v[20:23], a[96:99]
  v_mfma_f32_16x16x32_bf16 a[128:131], a[196:199], v[20:23], a[128:131]
  v_mfma_f32_16x16x32_bf16 a[4:7], a[180:183], v[24:27], a[4:7]
  v_perm_b32 v32, v165, v161, s63
  v_perm_b32 v33, v173, v169, s63
  v_mfma_f32_16x16x32_bf16 a[36:39], a[184:187], v[24:27], a[36:39]
  v_perm_b32 v34, v181, v177, s63
  v_perm_b32 v35, v189, v185, s63
  v_mfma_f32_16x16x32_bf16 a[68:71], a[188:191], v[24:27], a[68:71]
  ds_read_b128 a[164:167], v4 offset:4736
  v_mfma_f32_16x16x32_bf16 a[100:103], a[192:195], v[24:27], a[100:103]
  global_load_dwordx4 a[224:227], v3, s[80:81] offset:2048 sc1
  v_mfma_f32_16x16x32_bf16 a[132:135], a[196:199], v[24:27], a[132:135]
  v_mfma_f32_16x16x32_bf16 a[8:11], a[180:183], v[28:31], a[8:11]
  v_perm_b32 v20, v166, v162, s62
  v_perm_b32 v21, v174, v170, s62
  v_mfma_f32_16x16x32_bf16 a[40:43], a[184:187], v[28:31], a[40:43]
  v_perm_b32 v22, v182, v178, s62
  v_perm_b32 v23, v190, v186, s62
  v_mfma_f32_16x16x32_bf16 a[72:75], a[188:191], v[28:31], a[72:75]
  ds_read_b128 a[168:171], v5 offset:128
  v_mfma_f32_16x16x32_bf16 a[104:107], a[192:195], v[28:31], a[104:107]
  v_mfma_f32_16x16x32_bf16 a[136:139], a[196:199], v[28:31], a[136:139]
  global_load_dwordx4 a[228:231], v3, s[80:81] offset:3072 sc1
  v_mfma_f32_16x16x32_bf16 a[12:15], a[180:183], v[32:35], a[12:15]
  v_perm_b32 v24, v166, v162, s63
  v_perm_b32 v25, v174, v170, s63
  v_mfma_f32_16x16x32_bf16 a[44:47], a[184:187], v[32:35], a[44:47]
  v_perm_b32 v26, v182, v178, s63
  v_perm_b32 v27, v190, v186, s63
  v_mfma_f32_16x16x32_bf16 a[76:79], a[188:191], v[32:35], a[76:79]
  ds_read_b128 a[172:175], v5 offset:4736
  v_mfma_f32_16x16x32_bf16 a[108:111], a[192:195], v[32:35], a[108:111]
  v_mfma_f32_16x16x32_bf16 a[140:143], a[196:199], v[32:35], a[140:143]
  v_mfma_f32_16x16x32_bf16 a[16:19], a[180:183], v[20:23], a[16:19]
  v_add_u32 v3, 0x18000, v2
  global_load_dwordx4 v[64:67], v3, s[80:81] offset:0 sc1
  v_perm_b32 v28, v167, v163, s62
  v_perm_b32 v29, v175, v171, s62
  v_mfma_f32_16x16x32_bf16 a[48:51], a[184:187], v[20:23], a[48:51]
  v_perm_b32 v30, v183, v179, s62
  v_perm_b32 v31, v191, v187, s62
  v_mfma_f32_16x16x32_bf16 a[80:83], a[188:191], v[20:23], a[80:83]
  ds_read_b128 a[176:179], v6 offset:128
  v_mfma_f32_16x16x32_bf16 a[112:115], a[192:195], v[20:23], a[112:115]
  v_mfma_f32_16x16x32_bf16 a[144:147], a[196:199], v[20:23], a[144:147]
  v_mfma_f32_16x16x32_bf16 a[20:23], a[180:183], v[24:27], a[20:23]
  v_perm_b32 v32, v167, v163, s63
  global_load_dwordx4 v[68:71], v3, s[80:81] offset:1024 sc1
  v_perm_b32 v33, v175, v171, s63
  v_mfma_f32_16x16x32_bf16 a[52:55], a[184:187], v[24:27], a[52:55]
  v_perm_b32 v34, v183, v179, s63
  v_perm_b32 v35, v191, v187, s63
  v_mfma_f32_16x16x32_bf16 a[84:87], a[188:191], v[24:27], a[84:87]
  v_mfma_f32_16x16x32_bf16 a[116:119], a[192:195], v[24:27], a[116:119]
  v_mfma_f32_16x16x32_bf16 a[148:151], a[196:199], v[24:27], a[148:151]
  v_mfma_f32_16x16x32_bf16 a[24:27], a[180:183], v[28:31], a[24:27]
  s_waitcnt vmcnt(21)
  v_perm_b32 v20, v196, v192, s62
  v_mfma_f32_16x16x32_bf16 a[56:59], a[184:187], v[28:31], a[56:59]
  global_load_dwordx4 v[72:75], v3, s[80:81] offset:2048 sc1
  v_perm_b32 v21, v204, v200, s62
  v_perm_b32 v22, v212, v208, s62
  v_mfma_f32_16x16x32_bf16 a[88:91], a[188:191], v[28:31], a[88:91]
  v_perm_b32 v23, v220, v216, s62
  v_mfma_f32_16x16x32_bf16 a[120:123], a[192:195], v[28:31], a[120:123]
  v_mfma_f32_16x16x32_bf16 a[152:155], a[196:199], v[28:31], a[152:155]
  v_mfma_f32_16x16x32_bf16 a[28:31], a[180:183], v[32:35], a[28:31]
  v_perm_b32 v24, v196, v192, s63
  v_perm_b32 v25, v204, v200, s63
  v_mfma_f32_16x16x32_bf16 a[60:63], a[184:187], v[32:35], a[60:63]
  v_perm_b32 v26, v212, v208, s63
  global_load_dwordx4 v[76:79], v3, s[80:81] offset:3072 sc1
  v_perm_b32 v27, v220, v216, s63
  v_mfma_f32_16x16x32_bf16 a[92:95], a[188:191], v[32:35], a[92:95]
  v_mfma_f32_16x16x32_bf16 a[124:127], a[192:195], v[32:35], a[124:127]
  v_mfma_f32_16x16x32_bf16 a[156:159], a[196:199], v[32:35], a[156:159]
  s_waitcnt lgkmcnt(0)
  v_mfma_f32_16x16x32_bf16 a[0:3], a[160:163], v[20:23], a[0:3]
  v_perm_b32 v28, v197, v193, s62
  v_perm_b32 v29, v205, v201, s62
  v_mfma_f32_16x16x32_bf16 a[32:35], a[164:167], v[20:23], a[32:35]
  v_perm_b32 v30, v213, v209, s62
  v_perm_b32 v31, v221, v217, s62
  v_add_u32 v3, 0x1c000, v2
  global_load_dwordx4 v[80:83], v3, s[80:81] offset:0 sc1
  v_mfma_f32_16x16x32_bf16 a[64:67], a[168:171], v[20:23], a[64:67]
  ds_read_b128 a[180:183], v15 offset:0
  v_mfma_f32_16x16x32_bf16 a[96:99], a[172:175], v[20:23], a[96:99]
  v_mfma_f32_16x16x32_bf16 a[128:131], a[176:179], v[20:23], a[128:131]
  v_mfma_f32_16x16x32_bf16 a[4:7], a[160:163], v[24:27], a[4:7]
  v_perm_b32 v32, v197, v193, s63
  v_perm_b32 v33, v205, v201, s63
  v_mfma_f32_16x16x32_bf16 a[36:39], a[164:167], v[24:27], a[36:39]
  v_perm_b32 v34, v213, v209, s63
  v_perm_b32 v35, v221, v217, s63
  v_mfma_f32_16x16x32_bf16 a[68:71], a[168:171], v[24:27], a[68:71]
  global_load_dwordx4 v[84:87], v3, s[80:81] offset:1024 sc1
  ds_read_b128 a[184:187], v15 offset:4608
  v_mfma_f32_16x16x32_bf16 a[100:103], a[172:175], v[24:27], a[100:103]
  v_mfma_f32_16x16x32_bf16 a[132:135], a[176:179], v[24:27], a[132:135]
  v_mfma_f32_16x16x32_bf16 a[8:11], a[160:163], v[28:31], a[8:11]
  v_perm_b32 v20, v198, v194, s62
  v_perm_b32 v21, v206, v202, s62
  v_mfma_f32_16x16x32_bf16 a[40:43], a[164:167], v[28:31], a[40:43]
  v_perm_b32 v22, v214, v210, s62
  v_perm_b32 v23, v222, v218, s62
  v_mfma_f32_16x16x32_bf16 a[72:75], a[168:171], v[28:31], a[72:75]
  ds_read_b128 a[188:191], v16 offset:0
  global_load_dwordx4 v[88:91], v3, s[80:81] offset:2048 sc1
  v_mfma_f32_16x16x32_bf16 a[104:107], a[172:175], v[28:31], a[104:107]
  v_mfma_f32_16x16x32_bf16 a[136:139], a[176:179], v[28:31], a[136:139]
  v_mfma_f32_16x16x32_bf16 a[12:15], a[160:163], v[32:35], a[12:15]
  v_perm_b32 v24, v198, v194, s63
  v_perm_b32 v25, v206, v202, s63
  v_mfma_f32_16x16x32_bf16 a[44:47], a[164:167], v[32:35], a[44:47]
  v_perm_b32 v26, v214, v210, s63
  v_perm_b32 v27, v222, v218, s63
  v_mfma_f32_16x16x32_bf16 a[76:79], a[168:171], v[32:35], a[76:79]
  ds_read_b128 a[192:195], v16 offset:4608
  v_mfma_f32_16x16x32_bf16 a[108:111], a[172:175], v[32:35], a[108:111]
  global_load_dwordx4 v[92:95], v3, s[80:81] offset:3072 sc1
  v_mfma_f32_16x16x32_bf16 a[140:143], a[176:179], v[32:35], a[140:143]
  v_mfma_f32_16x16x32_bf16 a[16:19], a[160:163], v[20:23], a[16:19]
  v_perm_b32 v28, v199, v195, s62
  v_perm_b32 v29, v207, v203, s62
  v_mfma_f32_16x16x32_bf16 a[48:51], a[164:167], v[20:23], a[48:51]
  v_perm_b32 v30, v215, v211, s62
  v_perm_b32 v31, v223, v219, s62
  v_mfma_f32_16x16x32_bf16 a[80:83], a[168:171], v[20:23], a[80:83]
  ds_read_b128 a[196:199], v17 offset:0
  v_mfma_f32_16x16x32_bf16 a[112:115], a[172:175], v[20:23], a[112:115]
  v_mfma_f32_16x16x32_bf16 a[144:147], a[176:179], v[20:23], a[144:147]
  v_add_u32 v3, 0x20000, v2
  global_load_dwordx4 v[96:99], v3, s[80:81] offset:0 sc1
  v_mfma_f32_16x16x32_bf16 a[20:23], a[160:163], v[24:27], a[20:23]
  v_perm_b32 v32, v199, v195, s63
  v_perm_b32 v33, v207, v203, s63
  v_mfma_f32_16x16x32_bf16 a[52:55], a[164:167], v[24:27], a[52:55]
  v_perm_b32 v34, v215, v211, s63
  v_perm_b32 v35, v223, v219, s63
  v_mfma_f32_16x16x32_bf16 a[84:87], a[168:171], v[24:27], a[84:87]
  v_mfma_f32_16x16x32_bf16 a[116:119], a[172:175], v[24:27], a[116:119]
  v_mfma_f32_16x16x32_bf16 a[148:151], a[176:179], v[24:27], a[148:151]
  v_mfma_f32_16x16x32_bf16 a[24:27], a[160:163], v[28:31], a[24:27]
  s_waitcnt vmcnt(20)
  global_load_dwordx4 v[100:103], v3, s[80:81] offset:1024 sc1
  v_perm_b32 v20, v228, v224, s62
  v_mfma_f32_16x16x32_bf16 a[56:59], a[164:167], v[28:31], a[56:59]
  v_perm_b32 v21, v236, v232, s62
  v_perm_b32 v22, v244, v240, s62
  v_mfma_f32_16x16x32_bf16 a[88:91], a[168:171], v[28:31], a[88:91]
  v_perm_b32 v23, v252, v248, s62
  v_mfma_f32_16x16x32_bf16 a[120:123], a[172:175], v[28:31], a[120:123]
  v_mfma_f32_16x16x32_bf16 a[152:155], a[176:179], v[28:31], a[152:155]
  v_mfma_f32_16x16x32_bf16 a[28:31], a[160:163], v[32:35], a[28:31]
  v_perm_b32 v24, v228, v224, s63
  v_perm_b32 v25, v236, v232, s63
  global_load_dwordx4 v[104:107], v3, s[80:81] offset:2048 sc1
  v_mfma_f32_16x16x32_bf16 a[60:63], a[164:167], v[32:35], a[60:63]
  v_perm_b32 v26, v244, v240, s63
  v_perm_b32 v27, v252, v248, s63
  v_mfma_f32_16x16x32_bf16 a[92:95], a[168:171], v[32:35], a[92:95]
  v_mfma_f32_16x16x32_bf16 a[124:127], a[172:175], v[32:35], a[124:127]
  v_mfma_f32_16x16x32_bf16 a[156:159], a[176:179], v[32:35], a[156:159]
  s_waitcnt lgkmcnt(0)
  v_mfma_f32_16x16x32_bf16 a[0:3], a[180:183], v[20:23], a[0:3]
  v_perm_b32 v28, v229, v225, s62
  v_perm_b32 v29, v237, v233, s62
  v_mfma_f32_16x16x32_bf16 a[32:35], a[184:187], v[20:23], a[32:35]
  global_load_dwordx4 v[108:111], v3, s[80:81] offset:3072 sc1
  v_perm_b32 v30, v245, v241, s62
  v_perm_b32 v31, v253, v249, s62
  v_mfma_f32_16x16x32_bf16 a[64:67], a[188:191], v[20:23], a[64:67]
  v_mfma_f32_16x16x32_bf16 a[96:99], a[192:195], v[20:23], a[96:99]
  v_mfma_f32_16x16x32_bf16 a[128:131], a[196:199], v[20:23], a[128:131]
  v_mfma_f32_16x16x32_bf16 a[4:7], a[180:183], v[24:27], a[4:7]
  v_perm_b32 v32, v229, v225, s63
  v_perm_b32 v33, v237, v233, s63
  v_mfma_f32_16x16x32_bf16 a[36:39], a[184:187], v[24:27], a[36:39]
  v_perm_b32 v34, v245, v241, s63
  v_perm_b32 v35, v253, v249, s63
  v_add_u32 v3, 0x24000, v2
  global_load_dwordx4 v[112:115], v3, s[80:81] offset:0 sc1
  v_mfma_f32_16x16x32_bf16 a[68:71], a[188:191], v[24:27], a[68:71]
  v_mfma_f32_16x16x32_bf16 a[100:103], a[192:195], v[24:27], a[100:103]
  v_mfma_f32_16x16x32_bf16 a[132:135], a[196:199], v[24:27], a[132:135]
  v_mfma_f32_16x16x32_bf16 a[8:11], a[180:183], v[28:31], a[8:11]
  v_perm_b32 v20, v230, v226, s62
  v_perm_b32 v21, v238, v234, s62
  v_mfma_f32_16x16x32_bf16 a[40:43], a[184:187], v[28:31], a[40:43]
  v_perm_b32 v22, v246, v242, s62
  v_perm_b32 v23, v254, v250, s62
  v_mfma_f32_16x16x32_bf16 a[72:75], a[188:191], v[28:31], a[72:75]
  global_load_dwordx4 v[116:119], v3, s[80:81] offset:1024 sc1
  v_mfma_f32_16x16x32_bf16 a[104:107], a[192:195], v[28:31], a[104:107]
  v_mfma_f32_16x16x32_bf16 a[136:139], a[196:199], v[28:31], a[136:139]
  v_mfma_f32_16x16x32_bf16 a[12:15], a[180:183], v[32:35], a[12:15]
  v_perm_b32 v24, v230, v226, s63
  v_perm_b32 v25, v238, v234, s63
  v_mfma_f32_16x16x32_bf16 a[44:47], a[184:187], v[32:35], a[44:47]
  v_perm_b32 v26, v246, v242, s63
  v_perm_b32 v27, v254, v250, s63
  v_mfma_f32_16x16x32_bf16 a[76:79], a[188:191], v[32:35], a[76:79]
  v_mfma_f32_16x16x32_bf16 a[108:111], a[192:195], v[32:35], a[108:111]
  global_load_dwordx4 v[120:123], v3, s[80:81] offset:2048 sc1
  v_mfma_f32_16x16x32_bf16 a[140:143], a[196:199], v[32:35], a[140:143]
  v_mfma_f32_16x16x32_bf16 a[16:19], a[180:183], v[20:23], a[16:19]
  v_perm_b32 v28, v231, v227, s62
  v_perm_b32 v29, v239, v235, s62
  v_mfma_f32_16x16x32_bf16 a[48:51], a[184:187], v[20:23], a[48:51]
  v_perm_b32 v30, v247, v243, s62
  v_perm_b32 v31, v255, v251, s62
  v_mfma_f32_16x16x32_bf16 a[80:83], a[188:191], v[20:23], a[80:83]
  v_mfma_f32_16x16x32_bf16 a[112:115], a[192:195], v[20:23], a[112:115]
  v_mfma_f32_16x16x32_bf16 a[144:147], a[196:199], v[20:23], a[144:147]
  global_load_dwordx4 v[124:127], v3, s[80:81] offset:3072 sc1
  v_mfma_f32_16x16x32_bf16 a[20:23], a[180:183], v[24:27], a[20:23]
  v_perm_b32 v32, v231, v227, s63
  v_perm_b32 v33, v239, v235, s63
  v_mfma_f32_16x16x32_bf16 a[52:55], a[184:187], v[24:27], a[52:55]
  v_perm_b32 v34, v247, v243, s63
  v_perm_b32 v35, v255, v251, s63
  v_mfma_f32_16x16x32_bf16 a[84:87], a[188:191], v[24:27], a[84:87]
  v_mfma_f32_16x16x32_bf16 a[116:119], a[192:195], v[24:27], a[116:119]
  v_mfma_f32_16x16x32_bf16 a[148:151], a[196:199], v[24:27], a[148:151]
  v_mfma_f32_16x16x32_bf16 a[24:27], a[180:183], v[28:31], a[24:27]
  v_add_u32 v3, 0x28000, v2
  global_load_dwordx4 v[128:131], v3, s[80:81] offset:0 sc1
  v_mfma_f32_16x16x32_bf16 a[56:59], a[184:187], v[28:31], a[56:59]
  v_mfma_f32_16x16x32_bf16 a[88:91], a[188:191], v[28:31], a[88:91]
  v_mfma_f32_16x16x32_bf16 a[120:123], a[192:195], v[28:31], a[120:123]
  v_mfma_f32_16x16x32_bf16 a[152:155], a[196:199], v[28:31], a[152:155]
  v_mfma_f32_16x16x32_bf16 a[28:31], a[180:183], v[32:35], a[28:31]
  v_mfma_f32_16x16x32_bf16 a[60:63], a[184:187], v[32:35], a[60:63]
  v_mfma_f32_16x16x32_bf16 a[92:95], a[188:191], v[32:35], a[92:95]
  v_mfma_f32_16x16x32_bf16 a[124:127], a[192:195], v[32:35], a[124:127]
  global_load_dwordx4 v[132:135], v3, s[80:81] offset:1024 sc1
  v_mfma_f32_16x16x32_bf16 a[156:159], a[196:199], v[32:35], a[156:159]
  v_mov_b32 v12, 0xc0135761
  v_mov_b32 v13, 0xc0135761
  s_nop 7
  s_nop 1
  v_accvgpr_read_b32 v20, a128
  v_accvgpr_read_b32 v21, a132
  v_accvgpr_read_b32 v22, a136
  v_accvgpr_read_b32 v23, a140
  global_load_dwordx4 v[136:139], v3, s[80:81] offset:2048 sc1
  v_accvgpr_read_b32 v24, a144
  v_accvgpr_read_b32 v25, a148
  v_accvgpr_read_b32 v26, a152
  v_accvgpr_read_b32 v27, a156
  ds_write_b128 v7, a[64:67] offset:0
  ds_write_b128 v7, a[68:71] offset:1024
  ds_write_b128 v7, a[72:75] offset:2048
  ds_write_b128 v7, a[76:79] offset:3072
  global_load_dwordx4 v[140:143], v3, s[80:81] offset:3072 sc1
  ds_write_b128 v7, a[80:83] offset:4096
  ds_write_b128 v7, a[84:87] offset:5120
  ds_write_b128 v7, a[88:91] offset:6144
  ds_write_b128 v7, a[92:95] offset:7168
  ds_write_b128 v7, a[96:99] offset:8192
  v_add_u32 v3, 0x2c000, v2
  global_load_dwordx4 v[144:147], v3, s[80:81] offset:0 sc1
  ds_write_b128 v7, a[100:103] offset:9216
  ds_write_b128 v7, a[104:107] offset:10240
  ds_write_b128 v7, a[108:111] offset:11264
  ds_write_b128 v7, a[112:115] offset:12288
  ds_write_b128 v7, a[116:119] offset:13312
  global_load_dwordx4 v[148:151], v3, s[80:81] offset:1024 sc1
  ds_write_b128 v7, a[120:123] offset:14336
  ds_write_b128 v7, a[124:127] offset:15360
  ds_write_b128 v7, v[20:23] offset:16384
  ds_write_b128 v7, v[24:27] offset:17408
  v_lshrrev_b32 v16, 4, v14
  v_and_b32 v17, 15, v14
  global_load_dwordx4 v[152:155], v3, s[80:81] offset:2048 sc1
  s_mul_i32 s69, s58, 16896
  s_lshl_b32 s70, s57, 8
  v_mul_u32_u24 v16, 2112, v16
  v_lshl_add_u32 v17, v17, 4, s70
  v_add3_u32 v9, v16, v17, s69
  v_add_u32 v10, 0x8400, v17
  v_mov_b32 v36, 0
  v_mov_b32 v37, 0
  v_mov_b32 v38, 0
  v_mov_b32 v39, 0
  s_waitcnt lgkmcnt(0)
  s_nop 1
  v_mfma_f32_32x32x16_bf16 a[64:79], v[36:39], v[36:39], 0
  global_load_dwordx4 v[156:159], v3, s[80:81] offset:3072 sc1
  v_mfma_f32_32x32x16_bf16 a[80:95], v[36:39], v[36:39], 0
  v_mfma_f32_32x32x16_bf16 a[96:111], v[36:39], v[36:39], 0
  v_add_u32 v3, 0x30000, v2
  global_load_dwordx4 v[160:163], v3, s[80:81] offset:0 sc1
  v_mfma_f32_32x32x16_bf16 a[112:127], v[36:39], v[36:39], 0
  s_barrier
  global_load_dwordx4 v[164:167], v3, s[80:81] offset:1024 sc1
  ds_read_b128 v[20:23], v8 offset:0
  ds_read_b128 v[24:27], v8 offset:1024
  ds_read_b128 v[28:31], v8 offset:2048
  ds_read_b128 v[32:35], v8 offset:3072
  s_waitcnt lgkmcnt(2)
  v_accvgpr_read_b32 v44, a0
  v_accvgpr_read_b32 v45, a1
  v_accvgpr_read_b32 v46, a2
  v_accvgpr_read_b32 v47, a3
  v_pk_add_f32 v[20:21], v[20:21], v[44:45]
  v_pk_add_f32 v[22:23], v[22:23], v[46:47]
  v_accvgpr_read_b32 v44, a4
  v_accvgpr_read_b32 v45, a5
  v_accvgpr_read_b32 v46, a6
  v_accvgpr_read_b32 v47, a7
  global_load_dwordx4 v[168:171], v3, s[80:81] offset:2048 sc1
  v_pk_add_f32 v[24:25], v[24:25], v[44:45]
  v_pk_add_f32 v[26:27], v[26:27], v[46:47]
  v_pk_mul_f32 v[36:37], v[20:21], v[20:21]
  v_pk_mul_f32 v[38:39], v[22:23], v[22:23]
  v_pk_mul_f32 v[40:41], v[24:25], v[24:25]
  v_pk_mul_f32 v[42:43], v[26:27], v[26:27]
  v_pk_fma_f32 v[36:37], v[36:37], s[64:65], v[12:13]
  v_pk_fma_f32 v[38:39], v[38:39], s[64:65], v[12:13]
  v_pk_fma_f32 v[40:41], v[40:41], s[64:65], v[12:13]
  v_pk_fma_f32 v[42:43], v[42:43], s[64:65], v[12:13]
  v_pk_mul_f32 v[36:37], v[20:21], v[36:37]
  v_pk_mul_f32 v[38:39], v[22:23], v[38:39]
  v_pk_mul_f32 v[40:41], v[24:25], v[40:41]
  v_pk_mul_f32 v[42:43], v[26:27], v[42:43]
  global_load_dwordx4 v[172:175], v3, s[80:81] offset:3072 sc1
  v_exp_f32 v36, v36
  v_exp_f32 v37, v37
  v_exp_f32 v38, v38
  v_exp_f32 v39, v39
  v_exp_f32 v40, v40
  v_exp_f32 v41, v41
  v_exp_f32 v42, v42
  v_add_u32 v3, 0x34000, v2
  global_load_dwordx4 v[176:179], v3, s[80:81] offset:0 sc1
  v_exp_f32 v43, v43
  v_pk_add_f32 v[36:37], v[36:37], s[66:67]
  v_pk_add_f32 v[38:39], v[38:39], s[66:67]
  v_pk_add_f32 v[40:41], v[40:41], s[66:67]
  v_pk_add_f32 v[42:43], v[42:43], s[66:67]
  v_rcp_f32 v36, v36
  v_rcp_f32 v37, v37
  v_rcp_f32 v38, v38
  v_rcp_f32 v39, v39
  global_load_dwordx4 v[180:183], v3, s[80:81] offset:1024 sc1
  v_rcp_f32 v40, v40
  v_rcp_f32 v41, v41
  v_rcp_f32 v42, v42
  v_rcp_f32 v43, v43
  v_pk_mul_f32 v[36:37], v[20:21], v[36:37]
  v_pk_mul_f32 v[38:39], v[22:23], v[38:39]
  v_pk_mul_f32 v[40:41], v[24:25], v[40:41]
  v_pk_mul_f32 v[42:43], v[26:27], v[42:43]
  v_mul_f32 v36, v11, v36
  v_mul_f32 v40, v11, v40
  global_load_dwordx4 v[184:187], v3, s[80:81] offset:2048 sc1
  v_cvt_pk_bf16_f32 v48, v36, v40
  v_cvt_pk_bf16_f32 v52, v37, v41
  v_cvt_pk_bf16_f32 v56, v38, v42
  v_cvt_pk_bf16_f32 v60, v39, v43
  ds_read_b128 v[20:23], v8 offset:4096
  ds_read_b128 v[24:27], v8 offset:5120
  s_waitcnt lgkmcnt(2)
  v_accvgpr_read_b32 v44, a8
  v_accvgpr_read_b32 v45, a9
  v_accvgpr_read_b32 v46, a10
  v_accvgpr_read_b32 v47, a11
  v_pk_add_f32 v[28:29], v[28:29], v[44:45]
  v_pk_add_f32 v[30:31], v[30:31], v[46:47]
  v_accvgpr_read_b32 v44, a12
  v_accvgpr_read_b32 v45, a13
  global_load_dwordx4 v[188:191], v3, s[80:81] offset:3072 sc1
  v_accvgpr_read_b32 v46, a14
  v_accvgpr_read_b32 v47, a15
  v_pk_add_f32 v[32:33], v[32:33], v[44:45]
  v_pk_add_f32 v[34:35], v[34:35], v[46:47]
  v_pk_mul_f32 v[36:37], v[28:29], v[28:29]
  v_pk_mul_f32 v[38:39], v[30:31], v[30:31]
  v_pk_mul_f32 v[40:41], v[32:33], v[32:33]
  v_pk_mul_f32 v[42:43], v[34:35], v[34:35]
  v_pk_fma_f32 v[36:37], v[36:37], s[64:65], v[12:13]
  v_pk_fma_f32 v[38:39], v[38:39], s[64:65], v[12:13]
  v_pk_fma_f32 v[40:41], v[40:41], s[64:65], v[12:13]
  v_pk_fma_f32 v[42:43], v[42:43], s[64:65], v[12:13]
  v_pk_mul_f32 v[36:37], v[28:29], v[36:37]
  v_pk_mul_f32 v[38:39], v[30:31], v[38:39]
  v_add_u32 v3, 0x38000, v2
  global_load_dwordx4 v[192:195], v3, s[80:81] offset:0 sc1
  v_pk_mul_f32 v[40:41], v[32:33], v[40:41]
  v_pk_mul_f32 v[42:43], v[34:35], v[42:43]
  v_exp_f32 v36, v36
  v_exp_f32 v37, v37
  v_exp_f32 v38, v38
  v_exp_f32 v39, v39
  v_exp_f32 v40, v40
  v_exp_f32 v41, v41
  global_load_dwordx4 v[196:199], v3, s[80:81] offset:1024 sc1
  v_exp_f32 v42, v42
  v_exp_f32 v43, v43
  v_pk_add_f32 v[36:37], v[36:37], s[66:67]
  v_pk_add_f32 v[38:39], v[38:39], s[66:67]
  v_pk_add_f32 v[40:41], v[40:41], s[66:67]
  v_pk_add_f32 v[42:43], v[42:43], s[66:67]
  v_rcp_f32 v36, v36
  v_rcp_f32 v37, v37
  v_rcp_f32 v38, v38
  global_load_dwordx4 v[200:203], v3, s[80:81] offset:2048 sc1
  v_rcp_f32 v39, v39
  v_rcp_f32 v40, v40
  v_rcp_f32 v41, v41
  v_rcp_f32 v42, v42
  v_rcp_f32 v43, v43
  v_pk_mul_f32 v[36:37], v[28:29], v[36:37]
  v_pk_mul_f32 v[38:39], v[30:31], v[38:39]
  v_pk_mul_f32 v[40:41], v[32:33], v[40:41]
  v_pk_mul_f32 v[42:43], v[34:35], v[42:43]
  global_load_dwordx4 v[204:207], v3, s[80:81] offset:3072 sc1
  v_mul_f32 v36, v11, v36
  v_mul_f32 v40, v11, v40
  v_cvt_pk_bf16_f32 v49, v36, v40
  v_cvt_pk_bf16_f32 v53, v37, v41
  v_cvt_pk_bf16_f32 v57, v38, v42
  v_cvt_pk_bf16_f32 v61, v39, v43
  ds_read_b128 v[28:31], v8 offset:6144
  ds_read_b128 v[32:35], v8 offset:7168
  s_waitcnt lgkmcnt(2)
  v_accvgpr_read_b32 v44, a16
  v_accvgpr_read_b32 v45, a17
  v_accvgpr_read_b32 v46, a18
  v_accvgpr_read_b32 v47, a19
  v_pk_add_f32 v[20:21], v[20:21], v[44:45]
  v_pk_add_f32 v[22:23], v[22:23], v[46:47]
  v_add_u32 v3, 0x3c000, v2
  global_load_dwordx4 v[208:211], v3, s[80:81] offset:0 sc1
  v_accvgpr_read_b32 v44, a20
  v_accvgpr_read_b32 v45, a21
  v_accvgpr_read_b32 v46, a22
  v_accvgpr_read_b32 v47, a23
  v_pk_add_f32 v[24:25], v[24:25], v[44:45]
  v_pk_add_f32 v[26:27], v[26:27], v[46:47]
  v_pk_mul_f32 v[36:37], v[20:21], v[20:21]
  v_pk_mul_f32 v[38:39], v[22:23], v[22:23]
  v_pk_mul_f32 v[40:41], v[24:25], v[24:25]
  v_pk_mul_f32 v[42:43], v[26:27], v[26:27]
  v_pk_fma_f32 v[36:37], v[36:37], s[64:65], v[12:13]
  v_pk_fma_f32 v[38:39], v[38:39], s[64:65], v[12:13]
  v_pk_fma_f32 v[40:41], v[40:41], s[64:65], v[12:13]
  v_pk_fma_f32 v[42:43], v[42:43], s[64:65], v[12:13]
  global_load_dwordx4 v[212:215], v3, s[80:81] offset:1024 sc1
  v_pk_mul_f32 v[36:37], v[20:21], v[36:37]
  v_pk_mul_f32 v[38:39], v[22:23], v[38:39]
  v_pk_mul_f32 v[40:41], v[24:25], v[40:41]
  v_pk_mul_f32 v[42:43], v[26:27], v[42:43]
  v_exp_f32 v36, v36
  v_exp_f32 v37, v37
  v_exp_f32 v38, v38
  v_exp_f32 v39, v39
  v_exp_f32 v40, v40
  global_load_dwordx4 v[216:219], v3, s[80:81] offset:2048 sc1
  v_exp_f32 v41, v41
  v_exp_f32 v42, v42
  v_exp_f32 v43, v43
  v_pk_add_f32 v[36:37], v[36:37], s[66:67]
  v_pk_add_f32 v[38:39], v[38:39], s[66:67]
  v_pk_add_f32 v[40:41], v[40:41], s[66:67]
  v_pk_add_f32 v[42:43], v[42:43], s[66:67]
  v_rcp_f32 v36, v36
  v_rcp_f32 v37, v37
  global_load_dwordx4 v[220:223], v3, s[80:81] offset:3072 sc1
  v_rcp_f32 v38, v38
  v_rcp_f32 v39, v39
  v_rcp_f32 v40, v40
  v_rcp_f32 v41, v41
  v_rcp_f32 v42, v42
  v_rcp_f32 v43, v43
  v_pk_mul_f32 v[36:37], v[20:21], v[36:37]
  v_pk_mul_f32 v[38:39], v[22:23], v[38:39]
  v_add_u32 v3, 0x40000, v2
  global_load_dwordx4 v[224:227], v3, s[80:81] offset:0 sc1
  v_pk_mul_f32 v[40:41], v[24:25], v[40:41]
  v_pk_mul_f32 v[42:43], v[26:27], v[42:43]
  v_mul_f32 v36, v11, v36
  v_mul_f32 v40, v11, v40
  v_cvt_pk_bf16_f32 v50, v36, v40
  v_cvt_pk_bf16_f32 v54, v37, v41
  v_cvt_pk_bf16_f32 v58, v38, v42
  v_cvt_pk_bf16_f32 v62, v39, v43
  ds_read_b128 v[20:23], v8 offset:8192
  ds_read_b128 v[24:27], v8 offset:9216
  s_waitcnt lgkmcnt(2)
  v_accvgpr_read_b32 v44, a24
  v_accvgpr_read_b32 v45, a25
  v_accvgpr_read_b32 v46, a26
  v_accvgpr_read_b32 v47, a27
  global_load_dwordx4 v[228:231], v3, s[80:81] offset:1024 sc1
  v_pk_add_f32 v[28:29], v[28:29], v[44:45]
  v_pk_add_f32 v[30:31], v[30:31], v[46:47]
  v_accvgpr_read_b32 v44, a28
  v_accvgpr_read_b32 v45, a29
  v_accvgpr_read_b32 v46, a30
  v_accvgpr_read_b32 v47, a31
  v_pk_add_f32 v[32:33], v[32:33], v[44:45]
  v_pk_add_f32 v[34:35], v[34:35], v[46:47]
  v_pk_mul_f32 v[36:37], v[28:29], v[28:29]
  v_pk_mul_f32 v[38:39], v[30:31], v[30:31]
  v_pk_mul_f32 v[40:41], v[32:33], v[32:33]
  v_pk_mul_f32 v[42:43], v[34:35], v[34:35]
  v_pk_fma_f32 v[36:37], v[36:37], s[64:65], v[12:13]
  v_pk_fma_f32 v[38:39], v[38:39], s[64:65], v[12:13]
  global_load_dwordx4 v[232:235], v3, s[80:81] offset:2048 sc1
  v_pk_fma_f32 v[40:41], v[40:41], s[64:65], v[12:13]
  v_pk_fma_f32 v[42:43], v[42:43], s[64:65], v[12:13]
  v_pk_mul_f32 v[36:37], v[28:29], v[36:37]
  v_pk_mul_f32 v[38:39], v[30:31], v[38:39]
  v_pk_mul_f32 v[40:41], v[32:33], v[40:41]
  v_pk_mul_f32 v[42:43], v[34:35], v[42:43]
  v_exp_f32 v36, v36
  v_exp_f32 v37, v37
  v_exp_f32 v38, v38
  v_exp_f32 v39, v39
  global_load_dwordx4 v[236:239], v3, s[80:81] offset:3072 sc1
  v_exp_f32 v40, v40
  v_exp_f32 v41, v41
  v_exp_f32 v42, v42
  v_exp_f32 v43, v43
  v_pk_add_f32 v[36:37], v[36:37], s[66:67]
  v_pk_add_f32 v[38:39], v[38:39], s[66:67]
  v_pk_add_f32 v[40:41], v[40:41], s[66:67]
  v_pk_add_f32 v[42:43], v[42:43], s[66:67]
  v_rcp_f32 v36, v36
  v_add_u32 v3, 0x44000, v2
  global_load_dwordx4 v[240:243], v3, s[80:81] offset:0 sc1
  v_rcp_f32 v37, v37
  v_rcp_f32 v38, v38
  v_rcp_f32 v39, v39
  v_rcp_f32 v40, v40
  v_rcp_f32 v41, v41
  v_rcp_f32 v42, v42
  v_rcp_f32 v43, v43
  global_load_dwordx4 v[244:247], v3, s[80:81] offset:1024 sc1
  v_pk_mul_f32 v[36:37], v[28:29], v[36:37]
  v_pk_mul_f32 v[38:39], v[30:31], v[38:39]
  v_pk_mul_f32 v[40:41], v[32:33], v[40:41]
  v_pk_mul_f32 v[42:43], v[34:35], v[42:43]
  v_mul_f32 v36, v11, v36
  v_mul_f32 v40, v11, v40
  v_cvt_pk_bf16_f32 v51, v36, v40
  v_cvt_pk_bf16_f32 v55, v37, v41
  v_cvt_pk_bf16_f32 v59, v38, v42
  v_cvt_pk_bf16_f32 v63, v39, v43
  ds_read_b128 v[28:31], v8 offset:10240
  ds_read_b128 v[32:35], v8 offset:11264
  s_waitcnt lgkmcnt(2)
  v_accvgpr_read_b32 v44, a32
  v_accvgpr_read_b32 v45, a33
  global_load_dwordx4 v[248:251], v3, s[80:81] offset:2048 sc1
  v_accvgpr_read_b32 v46, a34
  v_accvgpr_read_b32 v47, a35
  v_pk_add_f32 v[20:21], v[20:21], v[44:45]
  v_pk_add_f32 v[22:23], v[22:23], v[46:47]
  v_accvgpr_read_b32 v44, a36
  v_accvgpr_read_b32 v45, a37
  v_accvgpr_read_b32 v46, a38
  v_accvgpr_read_b32 v47, a39
  v_pk_add_f32 v[24:25], v[24:25], v[44:45]
  v_pk_add_f32 v[26:27], v[26:27], v[46:47]
  v_pk_mul_f32 v[36:37], v[20:21], v[20:21]
  v_pk_mul_f32 v[38:39], v[22:23], v[22:23]
  v_pk_mul_f32 v[40:41], v[24:25], v[24:25]
  v_pk_mul_f32 v[42:43], v[26:27], v[26:27]
  global_load_dwordx4 v[252:255], v3, s[80:81] offset:3072 sc1
  v_pk_fma_f32 v[36:37], v[36:37], s[64:65], v[12:13]
  v_pk_fma_f32 v[38:39], v[38:39], s[64:65], v[12:13]
  v_pk_fma_f32 v[40:41], v[40:41], s[64:65], v[12:13]
  v_pk_fma_f32 v[42:43], v[42:43], s[64:65], v[12:13]
  v_pk_mul_f32 v[36:37], v[20:21], v[36:37]
  v_pk_mul_f32 v[38:39], v[22:23], v[38:39]
  v_pk_mul_f32 v[40:41], v[24:25], v[40:41]
  v_pk_mul_f32 v[42:43], v[26:27], v[42:43]
  v_exp_f32 v36, v36
  v_exp_f32 v37, v37
  v_exp_f32 v38, v38
  v_add_u32 v3, 0x48000, v2
  global_load_dwordx4 a[160:163], v3, s[80:81] offset:0 sc1
  v_exp_f32 v39, v39
  ds_write_b128 v9, v[48:51] offset:0
  v_exp_f32 v40, v40
  v_exp_f32 v41, v41
  v_exp_f32 v42, v42
  v_exp_f32 v43, v43
  ds_write_b128 v9, v[52:55] offset:528
  global_load_dwordx4 a[164:167], v3, s[80:81] offset:1024 sc1
  v_pk_add_f32 v[36:37], v[36:37], s[66:67]
  v_pk_add_f32 v[38:39], v[38:39], s[66:67]
  v_pk_add_f32 v[40:41], v[40:41], s[66:67]
  v_pk_add_f32 v[42:43], v[42:43], s[66:67]
  v_rcp_f32 v36, v36
  v_rcp_f32 v37, v37
  v_rcp_f32 v38, v38
  v_rcp_f32 v39, v39
  ds_write_b128 v9, v[56:59] offset:1056
  global_load_dwordx4 a[168:171], v3, s[80:81] offset:2048 sc1
  v_rcp_f32 v40, v40
  v_rcp_f32 v41, v41
  v_rcp_f32 v42, v42
  v_rcp_f32 v43, v43
  ds_write_b128 v9, v[60:63] offset:1584
  v_pk_mul_f32 v[36:37], v[20:21], v[36:37]
  v_pk_mul_f32 v[38:39], v[22:23], v[38:39]
  v_pk_mul_f32 v[40:41], v[24:25], v[40:41]
  global_load_dwordx4 a[172:175], v3, s[80:81] offset:3072 sc1
  v_pk_mul_f32 v[42:43], v[26:27], v[42:43]
  v_cvt_pk_bf16_f32 v48, v36, v40
  v_cvt_pk_bf16_f32 v52, v37, v41
  v_cvt_pk_bf16_f32 v56, v38, v42
  v_cvt_pk_bf16_f32 v60, v39, v43
  ds_read_b128 v[20:23], v8 offset:12288
  ds_read_b128 v[24:27], v8 offset:13312
  s_waitcnt lgkmcnt(2)
  v_accvgpr_read_b32 v44, a40
  v_accvgpr_read_b32 v45, a41
  v_accvgpr_read_b32 v46, a42
  v_accvgpr_read_b32 v47, a43
  v_pk_add_f32 v[28:29], v[28:29], v[44:45]
  v_pk_add_f32 v[30:31], v[30:31], v[46:47]
  v_accvgpr_read_b32 v44, a44
  v_add_u32 v3, 0x4c000, v2
  global_load_dwordx4 a[176:179], v3, s[80:81] offset:0 sc1
  v_accvgpr_read_b32 v45, a45
  v_accvgpr_read_b32 v46, a46
  v_accvgpr_read_b32 v47, a47
  v_pk_add_f32 v[32:33], v[32:33], v[44:45]
  v_pk_add_f32 v[34:35], v[34:35], v[46:47]
  v_pk_mul_f32 v[36:37], v[28:29], v[28:29]
  v_pk_mul_f32 v[38:39], v[30:31], v[30:31]
  v_pk_mul_f32 v[40:41], v[32:33], v[32:33]
  v_pk_mul_f32 v[42:43], v[34:35], v[34:35]
  v_pk_fma_f32 v[36:37], v[36:37], s[64:65], v[12:13]
  v_pk_fma_f32 v[38:39], v[38:39], s[64:65], v[12:13]
  v_pk_fma_f32 v[40:41], v[40:41], s[64:65], v[12:13]
  v_pk_fma_f32 v[42:43], v[42:43], s[64:65], v[12:13]
  v_pk_mul_f32 v[36:37], v[28:29], v[36:37]
  global_load_dwordx4 a[180:183], v3, s[80:81] offset:1024 sc1
  v_pk_mul_f32 v[38:39], v[30:31], v[38:39]
  v_pk_mul_f32 v[40:41], v[32:33], v[40:41]
  v_pk_mul_f32 v[42:43], v[34:35], v[42:43]
  v_exp_f32 v36, v36
  v_exp_f32 v37, v37
  v_exp_f32 v38, v38
  v_exp_f32 v39, v39
  v_exp_f32 v40, v40
  v_exp_f32 v41, v41
  global_load_dwordx4 a[184:187], v3, s[80:81] offset:2048 sc1
  v_exp_f32 v42, v42
  v_exp_f32 v43, v43
  v_pk_add_f32 v[36:37], v[36:37], s[66:67]
  v_pk_add_f32 v[38:39], v[38:39], s[66:67]
  v_pk_add_f32 v[40:41], v[40:41], s[66:67]
  v_pk_add_f32 v[42:43], v[42:43], s[66:67]
  v_rcp_f32 v36, v36
  v_rcp_f32 v37, v37
  v_rcp_f32 v38, v38
  global_load_dwordx4 a[188:191], v3, s[80:81] offset:3072 sc1
  v_rcp_f32 v39, v39
  v_rcp_f32 v40, v40
  v_rcp_f32 v41, v41
  v_rcp_f32 v42, v42
  v_rcp_f32 v43, v43
  v_pk_mul_f32 v[36:37], v[28:29], v[36:37]
  v_pk_mul_f32 v[38:39], v[30:31], v[38:39]
  v_pk_mul_f32 v[40:41], v[32:33], v[40:41]
  v_pk_mul_f32 v[42:43], v[34:35], v[42:43]
  v_cvt_pk_bf16_f32 v49, v36, v40
  v_cvt_pk_bf16_f32 v53, v37, v41
  v_cvt_pk_bf16_f32 v57, v38, v42
  v_cvt_pk_bf16_f32 v61, v39, v43
  ds_read_b128 v[28:31], v8 offset:14336
  ds_read_b128 v[32:35], v8 offset:15360
  s_waitcnt lgkmcnt(2)
  v_accvgpr_read_b32 v44, a48
  v_accvgpr_read_b32 v45, a49
  v_accvgpr_read_b32 v46, a50
  v_accvgpr_read_b32 v47, a51
  v_pk_add_f32 v[20:21], v[20:21], v[44:45]
  v_pk_add_f32 v[22:23], v[22:23], v[46:47]
  v_accvgpr_read_b32 v44, a52
  v_accvgpr_read_b32 v45, a53
  v_accvgpr_read_b32 v46, a54
  v_accvgpr_read_b32 v47, a55
  v_pk_add_f32 v[24:25], v[24:25], v[44:45]
  v_pk_add_f32 v[26:27], v[26:27], v[46:47]
  v_pk_mul_f32 v[36:37], v[20:21], v[20:21]
  v_pk_mul_f32 v[38:39], v[22:23], v[22:23]
  v_pk_mul_f32 v[40:41], v[24:25], v[24:25]
  v_pk_mul_f32 v[42:43], v[26:27], v[26:27]
  v_pk_fma_f32 v[36:37], v[36:37], s[64:65], v[12:13]
  v_pk_fma_f32 v[38:39], v[38:39], s[64:65], v[12:13]
  v_pk_fma_f32 v[40:41], v[40:41], s[64:65], v[12:13]
  v_pk_fma_f32 v[42:43], v[42:43], s[64:65], v[12:13]
  v_pk_mul_f32 v[36:37], v[20:21], v[36:37]
  v_pk_mul_f32 v[38:39], v[22:23], v[38:39]
  v_pk_mul_f32 v[40:41], v[24:25], v[40:41]
  v_pk_mul_f32 v[42:43], v[26:27], v[42:43]
  v_exp_f32 v36, v36
  v_exp_f32 v37, v37
  v_exp_f32 v38, v38
  v_exp_f32 v39, v39
  v_exp_f32 v40, v40
  v_exp_f32 v41, v41
  v_exp_f32 v42, v42
  v_exp_f32 v43, v43
  v_pk_add_f32 v[36:37], v[36:37], s[66:67]
  v_pk_add_f32 v[38:39], v[38:39], s[66:67]
  v_pk_add_f32 v[40:41], v[40:41], s[66:67]
  v_pk_add_f32 v[42:43], v[42:43], s[66:67]
  v_rcp_f32 v36, v36
  v_rcp_f32 v37, v37
  v_rcp_f32 v38, v38
  v_rcp_f32 v39, v39
  v_rcp_f32 v40, v40
  v_rcp_f32 v41, v41
  v_rcp_f32 v42, v42
  v_rcp_f32 v43, v43
  v_pk_mul_f32 v[36:37], v[20:21], v[36:37]
  v_pk_mul_f32 v[38:39], v[22:23], v[38:39]
  v_pk_mul_f32 v[40:41], v[24:25], v[40:41]
  v_pk_mul_f32 v[42:43], v[26:27], v[42:43]
  v_cvt_pk_bf16_f32 v50, v36, v40
  v_cvt_pk_bf16_f32 v54, v37, v41
  v_cvt_pk_bf16_f32 v58, v38, v42
  v_cvt_pk_bf16_f32 v62, v39, v43
  ds_read_b128 v[20:23], v8 offset:16384
  ds_read_b128 v[24:27], v8 offset:17408
  s_waitcnt lgkmcnt(2)
  v_accvgpr_read_b32 v44, a56
  v_accvgpr_read_b32 v45, a57
  v_accvgpr_read_b32 v46, a58
  v_accvgpr_read_b32 v47, a59
  v_pk_add_f32 v[28:29], v[28:29], v[44:45]
  v_pk_add_f32 v[30:31], v[30:31], v[46:47]
  v_accvgpr_read_b32 v44, a60
  v_accvgpr_read_b32 v45, a61
  v_accvgpr_read_b32 v46, a62
  v_accvgpr_read_b32 v47, a63
  v_pk_add_f32 v[32:33], v[32:33], v[44:45]
  v_pk_add_f32 v[34:35], v[34:35], v[46:47]
  v_pk_mul_f32 v[36:37], v[28:29], v[28:29]
  v_pk_mul_f32 v[38:39], v[30:31], v[30:31]
  v_pk_mul_f32 v[40:41], v[32:33], v[32:33]
  v_pk_mul_f32 v[42:43], v[34:35], v[34:35]
  v_pk_fma_f32 v[36:37], v[36:37], s[64:65], v[12:13]
  v_pk_fma_f32 v[38:39], v[38:39], s[64:65], v[12:13]
  v_pk_fma_f32 v[40:41], v[40:41], s[64:65], v[12:13]
  v_pk_fma_f32 v[42:43], v[42:43], s[64:65], v[12:13]
  v_pk_mul_f32 v[36:37], v[28:29], v[36:37]
  v_pk_mul_f32 v[38:39], v[30:31], v[38:39]
  v_pk_mul_f32 v[40:41], v[32:33], v[40:41]
  v_pk_mul_f32 v[42:43], v[34:35], v[42:43]
  v_exp_f32 v36, v36
  v_exp_f32 v37, v37
  v_exp_f32 v38, v38
  v_exp_f32 v39, v39
  v_exp_f32 v40, v40
  v_exp_f32 v41, v41
  v_exp_f32 v42, v42
  v_exp_f32 v43, v43
  v_pk_add_f32 v[36:37], v[36:37], s[66:67]
  v_pk_add_f32 v[38:39], v[38:39], s[66:67]
  v_pk_add_f32 v[40:41], v[40:41], s[66:67]
  v_pk_add_f32 v[42:43], v[42:43], s[66:67]
  v_rcp_f32 v36, v36
  v_rcp_f32 v37, v37
  v_rcp_f32 v38, v38
  v_rcp_f32 v39, v39
  v_rcp_f32 v40, v40
  v_rcp_f32 v41, v41
  v_rcp_f32 v42, v42
  v_rcp_f32 v43, v43
  v_pk_mul_f32 v[36:37], v[28:29], v[36:37]
  v_pk_mul_f32 v[38:39], v[30:31], v[38:39]
  v_pk_mul_f32 v[40:41], v[32:33], v[40:41]
  v_pk_mul_f32 v[42:43], v[34:35], v[42:43]
  v_cvt_pk_bf16_f32 v51, v36, v40
  v_cvt_pk_bf16_f32 v55, v37, v41
  v_cvt_pk_bf16_f32 v59, v38, v42
  v_cvt_pk_bf16_f32 v63, v39, v43
  s_waitcnt lgkmcnt(0)
  v_accvgpr_read_b32 v36, a128
  v_accvgpr_read_b32 v37, a132
  v_accvgpr_read_b32 v38, a136
  v_accvgpr_read_b32 v39, a140
  v_accvgpr_read_b32 v40, a144
  v_accvgpr_read_b32 v41, a148
  v_accvgpr_read_b32 v42, a152
  v_accvgpr_read_b32 v43, a156
  v_pk_add_f32 v[20:21], v[20:21], v[36:37]
  v_pk_add_f32 v[22:23], v[22:23], v[38:39]
  v_pk_add_f32 v[24:25], v[24:25], v[40:41]
  v_pk_add_f32 v[26:27], v[26:27], v[42:43]
  v_add_u32 v3, 0x50000, v2
  global_load_dwordx4 a[128:131], v3, s[80:81] offset:0 sc1
  v_pk_mul_f32 v[36:37], v[20:21], v[20:21]
  v_pk_mul_f32 v[38:39], v[22:23], v[22:23]
  v_pk_mul_f32 v[40:41], v[24:25], v[24:25]
  v_pk_mul_f32 v[42:43], v[26:27], v[26:27]
  v_pk_fma_f32 v[36:37], v[36:37], s[64:65], v[12:13]
  v_pk_fma_f32 v[38:39], v[38:39], s[64:65], v[12:13]
  v_pk_fma_f32 v[40:41], v[40:41], s[64:65], v[12:13]
  v_pk_fma_f32 v[42:43], v[42:43], s[64:65], v[12:13]
  v_pk_mul_f32 v[36:37], v[20:21], v[36:37]
  v_pk_mul_f32 v[38:39], v[22:23], v[38:39]
  v_pk_mul_f32 v[40:41], v[24:25], v[40:41]
  v_pk_mul_f32 v[42:43], v[26:27], v[42:43]
  v_exp_f32 v36, v36
  global_load_dwordx4 a[132:135], v3, s[80:81] offset:1024 sc1
  v_exp_f32 v37, v37
  v_exp_f32 v38, v38
  v_exp_f32 v39, v39
  ds_write_b128 v9, v[48:51] offset:8448
  v_exp_f32 v40, v40
  v_exp_f32 v41, v41
  v_exp_f32 v42, v42
  global_load_dwordx4 a[136:139], v3, s[80:81] offset:2048 sc1
  v_exp_f32 v43, v43
  ds_write_b128 v9, v[52:55] offset:8976
  v_pk_add_f32 v[36:37], v[36:37], s[66:67]
  v_pk_add_f32 v[38:39], v[38:39], s[66:67]
  v_pk_add_f32 v[40:41], v[40:41], s[66:67]
  v_pk_add_f32 v[42:43], v[42:43], s[66:67]
  v_rcp_f32 v36, v36
  v_rcp_f32 v37, v37
  v_rcp_f32 v38, v38
  global_load_dwordx4 a[140:143], v3, s[80:81] offset:3072 sc1
  v_rcp_f32 v39, v39
  ds_write_b128 v9, v[56:59] offset:9504
  v_rcp_f32 v40, v40
  v_rcp_f32 v41, v41
  v_rcp_f32 v42, v42
  v_rcp_f32 v43, v43
  ds_write_b128 v9, v[60:63] offset:10032
  v_add_u32 v3, 0x54000, v2
  global_load_dwordx4 a[144:147], v3, s[80:81] offset:0 sc1
  v_pk_mul_f32 v[36:37], v[20:21], v[36:37]
  v_pk_mul_f32 v[38:39], v[22:23], v[38:39]
  v_pk_mul_f32 v[40:41], v[24:25], v[40:41]
  v_pk_mul_f32 v[42:43], v[26:27], v[42:43]
  v_cvt_pk_bf16_f32 v28, v36, v37
  v_cvt_pk_bf16_f32 v29, v38, v39
  v_cvt_pk_bf16_f32 v30, v40, v41
  v_cvt_pk_bf16_f32 v31, v42, v43
  s_mov_b32 exec_lo, 0xffff
  s_mov_b32 exec_hi, 0
  ds_write_b128 v10, v[28:31]
  s_mov_b64 exec, -1
  v_lshrrev_b32 v16, 4, v14
  v_and_b32 v17, 15, v14
  global_load_dwordx4 a[148:151], v3, s[80:81] offset:1024 sc1
  v_mul_u32_u24 v4, 1056, v17
  v_lshl_add_u32 v4, v16, 4, v4
  v_mul_u32_u24 v5, 544, v17
  v_lshl_add_u32 v5, v16, 4, v5
  v_add_u32 v5, 0x1de00, v5
  s_waitcnt lgkmcnt(0)
  s_barrier
  global_load_dwordx4 a[152:155], v3, s[80:81] offset:2048 sc1
  s_lshl_b32 s69, s59, 4
  v_mov_b32 v15, s69
  v_mov_b32 v16, 32
  global_load_dwordx4 v[60:63], v15, s[84:85] sc0 sc1
  global_load_dwordx4 v[56:59], v16, s[84:85] sc0 sc1
  global_load_dwordx4 v[52:55], v16, s[84:85] offset:16 sc0 sc1
  global_load_dwordx4 a[156:159], v3, s[80:81] offset:3072 sc1
  ds_read_b128 a[0:3], v4 offset:0
  ds_read_b128 a[4:7], v4 offset:16896
  s_waitcnt vmcnt(63)
  s_waitcnt lgkmcnt(0)
  v_mfma_f32_16x16x32_bf16 a[64:67], a[0:3], a[200:203], a[64:67]
  ds_read_b128 a[8:11], v4 offset:64
  v_mfma_f32_16x16x32_bf16 a[80:83], a[4:7], a[200:203], a[80:83]
  ds_read_b128 a[12:15], v4 offset:16960
  v_mfma_f32_16x16x32_bf16 a[68:71], a[0:3], a[204:207], a[68:71]
  v_mfma_f32_16x16x32_bf16 a[84:87], a[4:7], a[204:207], a[84:87]
  v_mfma_f32_16x16x32_bf16 a[72:75], a[0:3], a[208:211], a[72:75]
  v_mfma_f32_16x16x32_bf16 a[88:91], a[4:7], a[208:211], a[88:91]
  v_mfma_f32_16x16x32_bf16 a[76:79], a[0:3], a[212:215], a[76:79]
  v_mfma_f32_16x16x32_bf16 a[92:95], a[4:7], a[212:215], a[92:95]
  s_waitcnt vmcnt(63)
  v_add_u32 v3, 0x58000, v2
  global_load_dwordx4 a[200:203], v3, s[80:81] offset:0 sc1
  s_waitcnt lgkmcnt(0)
  v_mfma_f32_16x16x32_bf16 a[64:67], a[8:11], a[216:219], a[64:67]
  ds_read_b128 a[0:3], v4 offset:128
  v_mfma_f32_16x16x32_bf16 a[80:83], a[12:15], a[216:219], a[80:83]
  ds_read_b128 a[4:7], v4 offset:17024
  v_mfma_f32_16x16x32_bf16 a[68:71], a[8:11], a[220:223], a[68:71]
  v_mfma_f32_16x16x32_bf16 a[84:87], a[12:15], a[220:223], a[84:87]
  v_mfma_f32_16x16x32_bf16 a[72:75], a[8:11], a[224:227], a[72:75]
  global_load_dwordx4 a[204:207], v3, s[80:81] offset:1024 sc1
  v_mfma_f32_16x16x32_bf16 a[88:91], a[12:15], a[224:227], a[88:91]
  v_mfma_f32_16x16x32_bf16 a[76:79], a[8:11], a[228:231], a[76:79]
  v_mfma_f32_16x16x32_bf16 a[92:95], a[12:15], a[228:231], a[92:95]
  s_waitcnt vmcnt(63)
  s_waitcnt lgkmcnt(0)
  v_mfma_f32_16x16x32_bf16 a[64:67], a[0:3], v[64:67], a[64:67]
  ds_read_b128 a[8:11], v4 offset:192
  v_mfma_f32_16x16x32_bf16 a[80:83], a[4:7], v[64:67], a[80:83]
  global_load_dwordx4 a[208:211], v3, s[80:81] offset:2048 sc1
  ds_read_b128 a[12:15], v4 offset:17088
  v_mfma_f32_16x16x32_bf16 a[68:71], a[0:3], v[68:71], a[68:71]
  v_mfma_f32_16x16x32_bf16 a[84:87], a[4:7], v[68:71], a[84:87]
  v_mfma_f32_16x16x32_bf16 a[72:75], a[0:3], v[72:75], a[72:75]
  v_mfma_f32_16x16x32_bf16 a[88:91], a[4:7], v[72:75], a[88:91]
  v_mfma_f32_16x16x32_bf16 a[76:79], a[0:3], v[76:79], a[76:79]
  v_mfma_f32_16x16x32_bf16 a[92:95], a[4:7], v[76:79], a[92:95]
  s_waitcnt vmcnt(62)
  global_load_dwordx4 a[212:215], v3, s[80:81] offset:3072 sc1
  s_waitcnt lgkmcnt(0)
  v_mfma_f32_16x16x32_bf16 a[64:67], a[8:11], v[80:83], a[64:67]
  ds_read_b128 a[0:3], v4 offset:256
  v_mfma_f32_16x16x32_bf16 a[80:83], a[12:15], v[80:83], a[80:83]
  ds_read_b128 a[4:7], v4 offset:17152
  v_mfma_f32_16x16x32_bf16 a[68:71], a[8:11], v[84:87], a[68:71]
  v_mfma_f32_16x16x32_bf16 a[84:87], a[12:15], v[84:87], a[84:87]
  v_mfma_f32_16x16x32_bf16 a[72:75], a[8:11], v[88:91], a[72:75]
  v_add_u32 v3, 0x5c000, v2
  global_load_dwordx4 a[216:219], v3, s[80:81] offset:0 sc1
  v_mfma_f32_16x16x32_bf16 a[88:91], a[12:15], v[88:91], a[88:91]
  v_mfma_f32_16x16x32_bf16 a[76:79], a[8:11], v[92:95], a[76:79]
  v_mfma_f32_16x16x32_bf16 a[92:95], a[12:15], v[92:95], a[92:95]
  s_waitcnt vmcnt(60)
  s_waitcnt lgkmcnt(0)
  v_mfma_f32_16x16x32_bf16 a[64:67], a[0:3], v[96:99], a[64:67]
  ds_read_b128 a[8:11], v4 offset:320
  v_mfma_f32_16x16x32_bf16 a[80:83], a[4:7], v[96:99], a[80:83]
  global_load_dwordx4 a[220:223], v3, s[80:81] offset:1024 sc1
  ds_read_b128 a[12:15], v4 offset:17216
  v_mfma_f32_16x16x32_bf16 a[68:71], a[0:3], v[100:103], a[68:71]
  v_mfma_f32_16x16x32_bf16 a[84:87], a[4:7], v[100:103], a[84:87]
  v_mfma_f32_16x16x32_bf16 a[72:75], a[0:3], v[104:107], a[72:75]
  v_mfma_f32_16x16x32_bf16 a[88:91], a[4:7], v[104:107], a[88:91]
  v_mfma_f32_16x16x32_bf16 a[76:79], a[0:3], v[108:111], a[76:79]
  v_mfma_f32_16x16x32_bf16 a[92:95], a[4:7], v[108:111], a[92:95]
  s_waitcnt vmcnt(57)
  global_load_dwordx4 a[224:227], v3, s[80:81] offset:2048 sc1
  s_waitcnt lgkmcnt(0)
  v_mfma_f32_16x16x32_bf16 a[64:67], a[8:11], v[112:115], a[64:67]
  ds_read_b128 a[0:3], v4 offset:384
  v_mfma_f32_16x16x32_bf16 a[80:83], a[12:15], v[112:115], a[80:83]
  ds_read_b128 a[4:7], v4 offset:17280
  v_mfma_f32_16x16x32_bf16 a[68:71], a[8:11], v[116:119], a[68:71]
  v_mfma_f32_16x16x32_bf16 a[84:87], a[12:15], v[116:119], a[84:87]
  v_mfma_f32_16x16x32_bf16 a[72:75], a[8:11], v[120:123], a[72:75]
  global_load_dwordx4 a[228:231], v3, s[80:81] offset:3072 sc1
  v_mfma_f32_16x16x32_bf16 a[88:91], a[12:15], v[120:123], a[88:91]
  v_mfma_f32_16x16x32_bf16 a[76:79], a[8:11], v[124:127], a[76:79]
  v_mfma_f32_16x16x32_bf16 a[92:95], a[12:15], v[124:127], a[92:95]
  s_waitcnt vmcnt(55)
  s_waitcnt lgkmcnt(0)
  v_mfma_f32_16x16x32_bf16 a[64:67], a[0:3], v[128:131], a[64:67]
  ds_read_b128 a[8:11], v4 offset:448
  v_mfma_f32_16x16x32_bf16 a[80:83], a[4:7], v[128:131], a[80:83]
  v_add_u32 v3, 0x60000, v2
  global_load_dwordx4 v[64:67], v3, s[80:81] offset:0 sc1
  ds_read_b128 a[12:15], v4 offset:17344
  v_mfma_f32_16x16x32_bf16 a[68:71], a[0:3], v[132:135], a[68:71]
  v_mfma_f32_16x16x32_bf16 a[84:87], a[4:7], v[132:135], a[84:87]
  v_mfma_f32_16x16x32_bf16 a[72:75], a[0:3], v[136:139], a[72:75]
  v_mfma_f32_16x16x32_bf16 a[88:91], a[4:7], v[136:139], a[88:91]
  v_mfma_f32_16x16x32_bf16 a[76:79], a[0:3], v[140:143], a[76:79]
  v_mfma_f32_16x16x32_bf16 a[92:95], a[4:7], v[140:143], a[92:95]
  s_waitcnt vmcnt(52)
  global_load_dwordx4 v[68:71], v3, s[80:81] offset:1024 sc1
  s_waitcnt lgkmcnt(0)
  v_mfma_f32_16x16x32_bf16 a[64:67], a[8:11], v[144:147], a[64:67]
  ds_read_b128 a[0:3], v4 offset:528
  v_mfma_f32_16x16x32_bf16 a[80:83], a[12:15], v[144:147], a[80:83]
  ds_read_b128 a[4:7], v4 offset:17424
  v_mfma_f32_16x16x32_bf16 a[68:71], a[8:11], v[148:151], a[68:71]
  v_mfma_f32_16x16x32_bf16 a[84:87], a[12:15], v[148:151], a[84:87]
  v_mfma_f32_16x16x32_bf16 a[72:75], a[8:11], v[152:155], a[72:75]
  global_load_dwordx4 v[72:75], v3, s[80:81] offset:2048 sc1
  v_mfma_f32_16x16x32_bf16 a[88:91], a[12:15], v[152:155], a[88:91]
  v_mfma_f32_16x16x32_bf16 a[76:79], a[8:11], v[156:159], a[76:79]
  v_mfma_f32_16x16x32_bf16 a[92:95], a[12:15], v[156:159], a[92:95]
  s_waitcnt vmcnt(50)
  s_waitcnt lgkmcnt(0)
  v_mfma_f32_16x16x32_bf16 a[64:67], a[0:3], v[160:163], a[64:67]
  ds_read_b128 a[8:11], v4 offset:592
  v_mfma_f32_16x16x32_bf16 a[80:83], a[4:7], v[160:163], a[80:83]
  global_load_dwordx4 v[76:79], v3, s[80:81] offset:3072 sc1
  ds_read_b128 a[12:15], v4 offset:17488
  v_mfma_f32_16x16x32_bf16 a[68:71], a[0:3], v[164:167], a[68:71]
  v_mfma_f32_16x16x32_bf16 a[84:87], a[4:7], v[164:167], a[84:87]
  v_mfma_f32_16x16x32_bf16 a[72:75], a[0:3], v[168:171], a[72:75]
  v_mfma_f32_16x16x32_bf16 a[88:91], a[4:7], v[168:171], a[88:91]
  v_mfma_f32_16x16x32_bf16 a[76:79], a[0:3], v[172:175], a[76:79]
  v_mfma_f32_16x16x32_bf16 a[92:95], a[4:7], v[172:175], a[92:95]
  s_waitcnt vmcnt(47)
  v_add_u32 v3, 0x64000, v2
  global_load_dwordx4 v[80:83], v3, s[80:81] offset:0 sc1
  s_waitcnt lgkmcnt(0)
  v_mfma_f32_16x16x32_bf16 a[64:67], a[8:11], v[176:179], a[64:67]
  ds_read_b128 a[0:3], v4 offset:656
  v_mfma_f32_16x16x32_bf16 a[80:83], a[12:15], v[176:179], a[80:83]
  ds_read_b128 a[4:7], v4 offset:17552
  v_mfma_f32_16x16x32_bf16 a[68:71], a[8:11], v[180:183], a[68:71]
  v_mfma_f32_16x16x32_bf16 a[84:87], a[12:15], v[180:183], a[84:87]
  v_mfma_f32_16x16x32_bf16 a[72:75], a[8:11], v[184:187], a[72:75]
  global_load_dwordx4 v[84:87], v3, s[80:81] offset:1024 sc1
  v_mfma_f32_16x16x32_bf16 a[88:91], a[12:15], v[184:187], a[88:91]
  v_mfma_f32_16x16x32_bf16 a[76:79], a[8:11], v[188:191], a[76:79]
  v_mfma_f32_16x16x32_bf16 a[92:95], a[12:15], v[188:191], a[92:95]
  s_waitcnt vmcnt(45)
  s_waitcnt lgkmcnt(0)
  v_mfma_f32_16x16x32_bf16 a[64:67], a[0:3], v[192:195], a[64:67]
  ds_read_b128 a[8:11], v4 offset:720
  v_mfma_f32_16x16x32_bf16 a[80:83], a[4:7], v[192:195], a[80:83]
  global_load_dwordx4 v[88:91], v3, s[80:81] offset:2048 sc1
  ds_read_b128 a[12:15], v4 offset:17616
  v_mfma_f32_16x16x32_bf16 a[68:71], a[0:3], v[196:199], a[68:71]
  v_mfma_f32_16x16x32_bf16 a[84:87], a[4:7], v[196:199], a[84:87]
  v_mfma_f32_16x16x32_bf16 a[72:75], a[0:3], v[200:203], a[72:75]
  v_mfma_f32_16x16x32_bf16 a[88:91], a[4:7], v[200:203], a[88:91]
  v_mfma_f32_16x16x32_bf16 a[76:79], a[0:3], v[204:207], a[76:79]
  v_mfma_f32_16x16x32_bf16 a[92:95], a[4:7], v[204:207], a[92:95]
  s_waitcnt vmcnt(42)
  global_load_dwordx4 v[92:95], v3, s[80:81] offset:3072 sc1
  s_waitcnt lgkmcnt(0)
  v_mfma_f32_16x16x32_bf16 a[64:67], a[8:11], v[208:211], a[64:67]
  ds_read_b128 a[0:3], v4 offset:784
  v_mfma_f32_16x16x32_bf16 a[80:83], a[12:15], v[208:211], a[80:83]
  ds_read_b128 a[4:7], v4 offset:17680
  v_mfma_f32_16x16x32_bf16 a[68:71], a[8:11], v[212:215], a[68:71]
  v_mfma_f32_16x16x32_bf16 a[84:87], a[12:15], v[212:215], a[84:87]
  v_mfma_f32_16x16x32_bf16 a[72:75], a[8:11], v[216:219], a[72:75]
  v_add_u32 v3, 0x68000, v2
  global_load_dwordx4 v[96:99], v3, s[80:81] offset:0 sc1
  v_mfma_f32_16x16x32_bf16 a[88:91], a[12:15], v[216:219], a[88:91]
  v_mfma_f32_16x16x32_bf16 a[76:79], a[8:11], v[220:223], a[76:79]
  v_mfma_f32_16x16x32_bf16 a[92:95], a[12:15], v[220:223], a[92:95]
  s_waitcnt vmcnt(18)
L_flag_chk:
  v_min_u32 v17, v60, v61
  v_min3_u32 v17, v62, v63, v17
  v_min3_u32 v17, v56, v57, v17
  v_min3_u32 v17, v58, v59, v17
  v_min3_u32 v17, v52, v53, v17
  v_min3_u32 v51, v54, v55, v17
  v_or3_b32 v17, v60, v61, v62
  v_or_b32 v17, v17, v63
  v_readfirstlane_b32 s69, v51
  v_readfirstlane_b32 s70, v17
  s_nop 3
  s_cmp_lg_u32 s69, 0
  s_cbranch_scc1 L_flag_ok
  s_sleep 4
  global_load_dwordx4 v[60:63], v15, s[84:85] sc0 sc1
  global_load_dwordx4 v[56:59], v16, s[84:85] sc0 sc1
  global_load_dwordx4 v[52:55], v16, s[84:85] offset:16 sc0 sc1
  s_waitcnt vmcnt(0)
  s_branch L_flag_chk
L_flag_ok:
  s_and_b32 s68, s70, 2
  s_lshl_b32 s69, s59, 14
  s_lshl_b32 s70, s56, 11
  s_add_u32 s69, s69, s70
  s_add_u32 s69, s69, 0
  v_lshlrev_b32 v16, 4, v14
  v_add_u32 v16, s69, v16
  s_add_u32 s70, s70, 155648
  s_mov_b32 m0, s70
  s_nop 0
  buffer_load_dwordx4 v16, s[88:91], 0 offen sc0 sc1 lds
  buffer_load_dwordx4 v16, s[88:91], 0 offen offset:1024 sc0 sc1 lds
  s_waitcnt vmcnt(42)
  global_load_dwordx4 v[100:103], v3, s[80:81] offset:1024 sc1
  s_waitcnt lgkmcnt(0)
  v_mfma_f32_16x16x32_bf16 a[64:67], a[0:3], v[224:227], a[64:67]
  ds_read_b128 a[8:11], v4 offset:848
  v_mfma_f32_16x16x32_bf16 a[80:83], a[4:7], v[224:227], a[80:83]
  ds_read_b128 a[12:15], v4 offset:17744
  v_mfma_f32_16x16x32_bf16 a[68:71], a[0:3], v[228:231], a[68:71]
  v_mfma_f32_16x16x32_bf16 a[84:87], a[4:7], v[228:231], a[84:87]
  v_mfma_f32_16x16x32_bf16 a[72:75], a[0:3], v[232:235], a[72:75]
  global_load_dwordx4 v[104:107], v3, s[80:81] offset:2048 sc1
  v_mfma_f32_16x16x32_bf16 a[88:91], a[4:7], v[232:235], a[88:91]
  v_mfma_f32_16x16x32_bf16 a[76:79], a[0:3], v[236:239], a[76:79]
  v_mfma_f32_16x16x32_bf16 a[92:95], a[4:7], v[236:239], a[92:95]
  s_waitcnt vmcnt(40)
  s_waitcnt lgkmcnt(0)
  v_mfma_f32_16x16x32_bf16 a[64:67], a[8:11], v[240:243], a[64:67]
  ds_read_b128 a[0:3], v4 offset:912
  v_mfma_f32_16x16x32_bf16 a[80:83], a[12:15], v[240:243], a[80:83]
  global_load_dwordx4 v[108:111], v3, s[80:81] offset:3072 sc1
  ds_read_b128 a[4:7], v4 offset:17808
  v_mfma_f32_16x16x32_bf16 a[68:71], a[8:11], v[244:247], a[68:71]
  v_mfma_f32_16x16x32_bf16 a[84:87], a[12:15], v[244:247], a[84:87]
  v_mfma_f32_16x16x32_bf16 a[72:75], a[8:11], v[248:251], a[72:75]
  v_mfma_f32_16x16x32_bf16 a[88:91], a[12:15], v[248:251], a[88:91]
  v_mfma_f32_16x16x32_bf16 a[76:79], a[8:11], v[252:255], a[76:79]
  v_mfma_f32_16x16x32_bf16 a[92:95], a[12:15], v[252:255], a[92:95]
  s_waitcnt vmcnt(37)
  v_add_u32 v3, 0x6c000, v2
  global_load_dwordx4 v[112:115], v3, s[80:81] offset:0 sc1
  s_waitcnt lgkmcnt(0)
  v_mfma_f32_16x16x32_bf16 a[64:67], a[0:3], a[160:163], a[64:67]
  ds_read_b128 a[8:11], v4 offset:976
  v_mfma_f32_16x16x32_bf16 a[80:83], a[4:7], a[160:163], a[80:83]
  ds_read_b128 a[12:15], v4 offset:17872
  v_mfma_f32_16x16x32_bf16 a[68:71], a[0:3], a[164:167], a[68:71]
  v_mfma_f32_16x16x32_bf16 a[84:87], a[4:7], a[164:167], a[84:87]
  v_mfma_f32_16x16x32_bf16 a[72:75], a[0:3], a[168:171], a[72:75]
  global_load_dwordx4 v[116:119], v3, s[80:81] offset:1024 sc1
  v_mfma_f32_16x16x32_bf16 a[88:91], a[4:7], a[168:171], a[88:91]
  v_mfma_f32_16x16x32_bf16 a[76:79], a[0:3], a[172:175], a[76:79]
  v_mfma_f32_16x16x32_bf16 a[92:95], a[4:7], a[172:175], a[92:95]
  s_waitcnt vmcnt(35)
  s_waitcnt lgkmcnt(0)
  v_mfma_f32_16x16x32_bf16 a[64:67], a[8:11], a[176:179], a[64:67]
  ds_read_b128 a[0:3], v4 offset:1056
  v_mfma_f32_16x16x32_bf16 a[80:83], a[12:15], a[176:179], a[80:83]
  global_load_dwordx4 v[120:123], v3, s[80:81] offset:2048 sc1
  ds_read_b128 a[4:7], v4 offset:17952
  v_mfma_f32_16x16x32_bf16 a[68:71], a[8:11], a[180:183], a[68:71]
  v_mfma_f32_16x16x32_bf16 a[84:87], a[12:15], a[180:183], a[84:87]
  v_mfma_f32_16x16x32_bf16 a[72:75], a[8:11], a[184:187], a[72:75]
  v_mfma_f32_16x16x32_bf16 a[88:91], a[12:15], a[184:187], a[88:91]
  v_mfma_f32_16x16x32_bf16 a[76:79], a[8:11], a[188:191], a[76:79]
  v_mfma_f32_16x16x32_bf16 a[92:95], a[12:15], a[188:191], a[92:95]
  s_waitcnt vmcnt(32)
  global_load_dwordx4 v[124:127], v3, s[80:81] offset:3072 sc1
  s_waitcnt lgkmcnt(0)
  v_mfma_f32_16x16x32_bf16 a[64:67], a[0:3], a[128:131], a[64:67]
  ds_read_b128 a[8:11], v4 offset:1120
  v_mfma_f32_16x16x32_bf16 a[80:83], a[4:7], a[128:131], a[80:83]
  ds_read_b128 a[12:15], v4 offset:18016
  v_mfma_f32_16x16x32_bf16 a[68:71], a[0:3], a[132:135], a[68:71]
  v_mfma_f32_16x16x32_bf16 a[84:87], a[4:7], a[132:135], a[84:87]
  v_mfma_f32_16x16x32_bf16 a[72:75], a[0:3], a[136:139], a[72:75]
  v_add_u32 v3, 0x70000, v2
  global_load_dwordx4 v[128:131], v3, s[80:81] offset:0 sc1
  v_mfma_f32_16x16x32_bf16 a[88:91], a[4:7], a[136:139], a[88:91]
  v_mfma_f32_16x16x32_bf16 a[76:79], a[0:3], a[140:143], a[76:79]
  v_mfma_f32_16x16x32_bf16 a[92:95], a[4:7], a[140:143], a[92:95]
  s_waitcnt vmcnt(27)
  s_waitcnt lgkmcnt(0)
  v_mfma_f32_16x16x32_bf16 a[64:67], a[8:11], a[144:147], a[64:67]
  ds_read_b128 a[0:3], v4 offset:1184
  v_mfma_f32_16x16x32_bf16 a[80:83], a[12:15], a[144:147], a[80:83]
  global_load_dwordx4 v[132:135], v3, s[80:81] offset:1024 sc1
  ds_read_b128 a[4:7], v4 offset:18080
  v_mfma_f32_16x16x32_bf16 a[68:71], a[8:11], a[148:151], a[68:71]
  v_mfma_f32_16x16x32_bf16 a[84:87], a[12:15], a[148:151], a[84:87]
  v_mfma_f32_16x16x32_bf16 a[72:75], a[8:11], a[152:155], a[72:75]
  v_mfma_f32_16x16x32_bf16 a[88:91], a[12:15], a[152:155], a[88:91]
  v_mfma_f32_16x16x32_bf16 a[76:79], a[8:11], a[156:159], a[76:79]
  v_mfma_f32_16x16x32_bf16 a[92:95], a[12:15], a[156:159], a[92:95]
  s_waitcnt vmcnt(24)
  global_load_dwordx4 v[136:139], v3, s[80:81] offset:2048 sc1
  s_waitcnt lgkmcnt(0)
  v_mfma_f32_16x16x32_bf16 a[64:67], a[0:3], a[200:203], a[64:67]
  ds_read_b128 a[8:11], v4 offset:1248
  v_mfma_f32_16x16x32_bf16 a[80:83], a[4:7], a[200:203], a[80:83]
  ds_read_b128 a[12:15], v4 offset:18144
  v_mfma_f32_16x16x32_bf16 a[68:71], a[0:3], a[204:207], a[68:71]
  v_mfma_f32_16x16x32_bf16 a[84:87], a[4:7], a[204:207], a[84:87]
  v_mfma_f32_16x16x32_bf16 a[72:75], a[0:3], a[208:211], a[72:75]
  global_load_dwordx4 v[140:143], v3, s[80:81] offset:3072 sc1
  v_mfma_f32_16x16x32_bf16 a[88:91], a[4:7], a[208:211], a[88:91]
  v_mfma_f32_16x16x32_bf16 a[76:79], a[0:3], a[212:215], a[76:79]
  v_mfma_f32_16x16x32_bf16 a[92:95], a[4:7], a[212:215], a[92:95]
  s_waitcnt vmcnt(22)
  s_waitcnt lgkmcnt(0)
  v_mfma_f32_16x16x32_bf16 a[64:67], a[8:11], a[216:219], a[64:67]
  ds_read_b128 a[0:3], v4 offset:1312
  v_mfma_f32_16x16x32_bf16 a[80:83], a[12:15], a[216:219], a[80:83]
  v_add_u32 v3, 0x74000, v2
  global_load_dwordx4 v[144:147], v3, s[80:81] offset:0 sc1
  ds_read_b128 a[4:7], v4 offset:18208
  v_mfma_f32_16x16x32_bf16 a[68:71], a[8:11], a[220:223], a[68:71]
  v_mfma_f32_16x16x32_bf16 a[84:87], a[12:15], a[220:223], a[84:87]
  v_mfma_f32_16x16x32_bf16 a[72:75], a[8:11], a[224:227], a[72:75]
  v_mfma_f32_16x16x32_bf16 a[88:91], a[12:15], a[224:227], a[88:91]
  v_mfma_f32_16x16x32_bf16 a[76:79], a[8:11], a[228:231], a[76:79]
  v_mfma_f32_16x16x32_bf16 a[92:95], a[12:15], a[228:231], a[92:95]
  s_waitcnt vmcnt(19)
  global_load_dwordx4 v[148:151], v3, s[80:81] offset:1024 sc1
  s_waitcnt lgkmcnt(0)
  v_mfma_f32_16x16x32_bf16 a[64:67], a[0:3], v[64:67], a[64:67]
  ds_read_b128 a[8:11], v4 offset:1376
  v_mfma_f32_16x16x32_bf16 a[80:83], a[4:7], v[64:67], a[80:83]
  ds_read_b128 a[12:15], v4 offset:18272
  v_mfma_f32_16x16x32_bf16 a[68:71], a[0:3], v[68:71], a[68:71]
  v_mfma_f32_16x16x32_bf16 a[84:87], a[4:7], v[68:71], a[84:87]
  v_mfma_f32_16x16x32_bf16 a[72:75], a[0:3], v[72:75], a[72:75]
  global_load_dwordx4 v[152:155], v3, s[80:81] offset:2048 sc1
  v_mfma_f32_16x16x32_bf16 a[88:91], a[4:7], v[72:75], a[88:91]
  v_mfma_f32_16x16x32_bf16 a[76:79], a[0:3], v[76:79], a[76:79]
  v_mfma_f32_16x16x32_bf16 a[92:95], a[4:7], v[76:79], a[92:95]
  s_waitcnt vmcnt(17)
  s_waitcnt lgkmcnt(0)
  v_mfma_f32_16x16x32_bf16 a[64:67], a[8:11], v[80:83], a[64:67]
  ds_read_b128 a[0:3], v4 offset:1440
  v_mfma_f32_16x16x32_bf16 a[80:83], a[12:15], v[80:83], a[80:83]
  global_load_dwordx4 v[156:159], v3, s[80:81] offset:3072 sc1
  ds_read_b128 a[4:7], v4 offset:18336
  v_mfma_f32_16x16x32_bf16 a[68:71], a[8:11], v[84:87], a[68:71]
  v_mfma_f32_16x16x32_bf16 a[84:87], a[12:15], v[84:87], a[84:87]
  v_mfma_f32_16x16x32_bf16 a[72:75], a[8:11], v[88:91], a[72:75]
  v_mfma_f32_16x16x32_bf16 a[88:91], a[12:15], v[88:91], a[88:91]
  v_mfma_f32_16x16x32_bf16 a[76:79], a[8:11], v[92:95], a[76:79]
  v_mfma_f32_16x16x32_bf16 a[92:95], a[12:15], v[92:95], a[92:95]
  s_waitcnt vmcnt(12)
  v_add_u32 v3, 0x78000, v2
  global_load_dwordx4 v[160:163], v3, s[80:81] offset:0 sc1
  s_waitcnt lgkmcnt(0)
  v_mfma_f32_16x16x32_bf16 a[64:67], a[0:3], v[96:99], a[64:67]
  ds_read_b128 a[8:11], v4 offset:1504
  v_mfma_f32_16x16x32_bf16 a[80:83], a[4:7], v[96:99], a[80:83]
  ds_read_b128 a[12:15], v4 offset:18400
  v_mfma_f32_16x16x32_bf16 a[68:71], a[0:3], v[100:103], a[68:71]
  v_mfma_f32_16x16x32_bf16 a[84:87], a[4:7], v[100:103], a[84:87]
  v_mfma_f32_16x16x32_bf16 a[72:75], a[0:3], v[104:107], a[72:75]
  global_load_dwordx4 v[164:167], v3, s[80:81] offset:1024 sc1
  v_mfma_f32_16x16x32_bf16 a[88:91], a[4:7], v[104:107], a[88:91]
  v_mfma_f32_16x16x32_bf16 a[76:79], a[0:3], v[108:111], a[76:79]
  v_mfma_f32_16x16x32_bf16 a[92:95], a[4:7], v[108:111], a[92:95]
  s_waitcnt vmcnt(10)
  s_waitcnt lgkmcnt(0)
  v_mfma_f32_16x16x32_bf16 a[64:67], a[8:11], v[112:115], a[64:67]
  v_mfma_f32_16x16x32_bf16 a[80:83], a[12:15], v[112:115], a[80:83]
  v_mfma_f32_16x16x32_bf16 a[68:71], a[8:11], v[116:119], a[68:71]
  global_load_dwordx4 v[168:171], v3, s[80:81] offset:2048 sc1
  v_mfma_f32_16x16x32_bf16 a[84:87], a[12:15], v[116:119], a[84:87]
  v_mfma_f32_16x16x32_bf16 a[72:75], a[8:11], v[120:123], a[72:75]
  v_mfma_f32_16x16x32_bf16 a[88:91], a[12:15], v[120:123], a[88:91]
  v_mfma_f32_16x16x32_bf16 a[76:79], a[8:11], v[124:127], a[76:79]
  v_mfma_f32_16x16x32_bf16 a[92:95], a[12:15], v[124:127], a[92:95]
  v_mov_b32 v60, 0
  v_mov_b32 v61, 0
  global_load_dwordx4 v[172:175], v3, s[80:81] offset:3072 sc1
  v_mov_b32 v62, 0
  v_mov_b32 v63, 0
  s_nop 1
  v_mfma_f32_32x32x16_bf16 a[32:47], v[60:63], v[60:63], 0
  v_mfma_f32_32x32x16_bf16 a[48:63], v[60:63], v[60:63], 0
  v_add_u32 v3, 0x7c000, v2
  global_load_dwordx4 v[176:179], v3, s[80:81] offset:0 sc1
  s_nop 3
  v_lshrrev_b32 v16, 4, v14
  v_and_b32 v17, 15, v14
  s_lshl_b32 s69, s58, 8
  s_lshl_b32 s70, s57, 3
  s_add_u32 s69, s69, s70
  s_add_u32 s69, s69, 122368
  v_mul_u32_u24 v16, 2176, v16
  v_lshl_add_u32 v16, v17, 4, v16
  v_add_u32 v9, s69, v16
  v_accvgpr_read_b32 v20, a64
  v_accvgpr_read_b32 v21, a65
  v_accvgpr_read_b32 v22, a66
  global_load_dwordx4 v[180:183], v3, s[80:81] offset:1024 sc1
  v_accvgpr_read_b32 v23, a67
  v_accvgpr_read_b32 v24, a68
  v_accvgpr_read_b32 v25, a69
  v_accvgpr_read_b32 v26, a70
  v_accvgpr_read_b32 v27, a71
  v_accvgpr_read_b32 v28, a72
  v_accvgpr_read_b32 v29, a73
  v_accvgpr_read_b32 v30, a74
  v_accvgpr_read_b32 v31, a75
  v_accvgpr_read_b32 v32, a76
  v_accvgpr_read_b32 v33, a77
  v_accvgpr_read_b32 v34, a78
  v_accvgpr_read_b32 v35, a79
  v_pk_mul_f32 v[36:37], v[20:21], v[20:21]
  global_load_dwordx4 v[184:187], v3, s[80:81] offset:2048 sc1
  v_pk_mul_f32 v[38:39], v[22:23], v[22:23]
  v_pk_mul_f32 v[40:41], v[24:25], v[24:25]
  v_pk_mul_f32 v[42:43], v[26:27], v[26:27]
  v_pk_fma_f32 v[36:37], v[36:37], s[64:65], v[12:13]
  v_pk_fma_f32 v[38:39], v[38:39], s[64:65], v[12:13]
  v_pk_fma_f32 v[40:41], v[40:41], s[64:65], v[12:13]
  v_pk_fma_f32 v[42:43], v[42:43], s[64:65], v[12:13]
  v_pk_mul_f32 v[36:37], v[20:21], v[36:37]
  v_pk_mul_f32 v[38:39], v[22:23], v[38:39]
  v_pk_mul_f32 v[40:41], v[24:25], v[40:41]
  v_pk_mul_f32 v[42:43], v[26:27], v[42:43]
  v_exp_f32 v36, v36
  v_exp_f32 v37, v37
  global_load_dwordx4 v[188:191], v3, s[80:81] offset:3072 sc1
  v_exp_f32 v38, v38
  v_exp_f32 v39, v39
  v_exp_f32 v40, v40
  v_exp_f32 v41, v41
  v_exp_f32 v42, v42
  v_exp_f32 v43, v43
  v_pk_add_f32 v[36:37], v[36:37], s[66:67]
  v_pk_add_f32 v[38:39], v[38:39], s[66:67]
  v_add_u32 v3, 0x80000, v2
  global_load_dwordx4 v[192:195], v3, s[80:81] offset:0 sc1
  v_pk_add_f32 v[40:41], v[40:41], s[66:67]
  v_pk_add_f32 v[42:43], v[42:43], s[66:67]
  v_rcp_f32 v36, v36
  v_rcp_f32 v37, v37
  v_rcp_f32 v38, v38
  v_rcp_f32 v39, v39
  v_rcp_f32 v40, v40
  v_rcp_f32 v41, v41
  global_load_dwordx4 v[196:199], v3, s[80:81] offset:1024 sc1
  v_rcp_f32 v42, v42
  v_rcp_f32 v43, v43
  v_pk_mul_f32 v[36:37], v[20:21], v[36:37]
  v_pk_mul_f32 v[38:39], v[22:23], v[38:39]
  v_pk_mul_f32 v[40:41], v[24:25], v[40:41]
  v_pk_mul_f32 v[42:43], v[26:27], v[42:43]
  v_pk_mul_f32 v[44:45], v[28:29], v[28:29]
  v_pk_mul_f32 v[46:47], v[30:31], v[30:31]
  v_pk_mul_f32 v[48:49], v[32:33], v[32:33]
  v_pk_mul_f32 v[50:51], v[34:35], v[34:35]
  v_pk_fma_f32 v[44:45], v[44:45], s[64:65], v[12:13]
  v_pk_fma_f32 v[46:47], v[46:47], s[64:65], v[12:13]
  global_load_dwordx4 v[200:203], v3, s[80:81] offset:2048 sc1
  v_pk_fma_f32 v[48:49], v[48:49], s[64:65], v[12:13]
  v_pk_fma_f32 v[50:51], v[50:51], s[64:65], v[12:13]
  v_pk_mul_f32 v[44:45], v[28:29], v[44:45]
  v_pk_mul_f32 v[46:47], v[30:31], v[46:47]
  v_pk_mul_f32 v[48:49], v[32:33], v[48:49]
  v_pk_mul_f32 v[50:51], v[34:35], v[50:51]
  v_exp_f32 v44, v44
  v_exp_f32 v45, v45
  v_exp_f32 v46, v46
  v_exp_f32 v47, v47
  global_load_dwordx4 v[204:207], v3, s[80:81] offset:3072 sc1
  v_exp_f32 v48, v48
  v_exp_f32 v49, v49
  v_exp_f32 v50, v50
  v_exp_f32 v51, v51
  v_pk_add_f32 v[44:45], v[44:45], s[66:67]
  v_pk_add_f32 v[46:47], v[46:47], s[66:67]
  v_pk_add_f32 v[48:49], v[48:49], s[66:67]
  v_pk_add_f32 v[50:51], v[50:51], s[66:67]
  v_rcp_f32 v44, v44
  v_add_u32 v3, 0x84000, v2
  global_load_dwordx4 v[208:211], v3, s[80:81] offset:0 sc1
  v_rcp_f32 v45, v45
  v_rcp_f32 v46, v46
  v_rcp_f32 v47, v47
  v_rcp_f32 v48, v48
  v_rcp_f32 v49, v49
  v_rcp_f32 v50, v50
  v_rcp_f32 v51, v51
  global_load_dwordx4 v[212:215], v3, s[80:81] offset:1024 sc1
  v_pk_mul_f32 v[44:45], v[28:29], v[44:45]
  v_pk_mul_f32 v[46:47], v[30:31], v[46:47]
  v_pk_mul_f32 v[48:49], v[32:33], v[48:49]
  v_pk_mul_f32 v[50:51], v[34:35], v[50:51]
  v_cvt_pk_bf16_f32 v52, v36, v40
  v_cvt_pk_bf16_f32 v53, v44, v48
  v_cvt_pk_bf16_f32 v54, v37, v41
  v_cvt_pk_bf16_f32 v55, v45, v49
  v_cvt_pk_bf16_f32 v56, v38, v42
  v_cvt_pk_bf16_f32 v57, v46, v50
  v_cvt_pk_bf16_f32 v58, v39, v43
  v_cvt_pk_bf16_f32 v59, v47, v51
  v_accvgpr_read_b32 v20, a80
  v_accvgpr_read_b32 v21, a81
  global_load_dwordx4 v[216:219], v3, s[80:81] offset:2048 sc1
  v_accvgpr_read_b32 v22, a82
  v_accvgpr_read_b32 v23, a83
  v_accvgpr_read_b32 v24, a84
  v_accvgpr_read_b32 v25, a85
  v_accvgpr_read_b32 v26, a86
  v_accvgpr_read_b32 v27, a87
  v_accvgpr_read_b32 v28, a88
  v_accvgpr_read_b32 v29, a89
  v_accvgpr_read_b32 v30, a90
  v_accvgpr_read_b32 v31, a91
  v_accvgpr_read_b32 v32, a92
  v_accvgpr_read_b32 v33, a93
  v_accvgpr_read_b32 v34, a94
  v_accvgpr_read_b32 v35, a95
  global_load_dwordx4 v[220:223], v3, s[80:81] offset:3072 sc1
  v_pk_mul_f32 v[36:37], v[20:21], v[20:21]
  v_pk_mul_f32 v[38:39], v[22:23], v[22:23]
  v_pk_mul_f32 v[40:41], v[24:25], v[24:25]
  v_pk_mul_f32 v[42:43], v[26:27], v[26:27]
  v_pk_fma_f32 v[36:37], v[36:37], s[64:65], v[12:13]
  v_pk_fma_f32 v[38:39], v[38:39], s[64:65], v[12:13]
  v_pk_fma_f32 v[40:41], v[40:41], s[64:65], v[12:13]
  v_pk_fma_f32 v[42:43], v[42:43], s[64:65], v[12:13]
  v_pk_mul_f32 v[36:37], v[20:21], v[36:37]
  v_pk_mul_f32 v[38:39], v[22:23], v[38:39]
  v_pk_mul_f32 v[40:41], v[24:25], v[40:41]
  v_pk_mul_f32 v[42:43], v[26:27], v[42:43]
  v_exp_f32 v36, v36
  v_add_u32 v3, 0x88000, v2
  global_load_dwordx4 v[224:227], v3, s[80:81] offset:0 sc1
  v_exp_f32 v37, v37
  v_exp_f32 v38, v38
  v_exp_f32 v39, v39
  ds_write_b64 v9, v[52:53] offset:0
  v_exp_f32 v40, v40
  v_exp_f32 v41, v41
  v_exp_f32 v42, v42
  v_exp_f32 v43, v43
  global_load_dwordx4 v[228:231], v3, s[80:81] offset:1024 sc1
  ds_write_b64 v9, v[54:55] offset:544
  v_pk_add_f32 v[36:37], v[36:37], s[66:67]
  v_pk_add_f32 v[38:39], v[38:39], s[66:67]
  v_pk_add_f32 v[40:41], v[40:41], s[66:67]
  v_pk_add_f32 v[42:43], v[42:43], s[66:67]
  v_rcp_f32 v36, v36
  v_rcp_f32 v37, v37
  v_rcp_f32 v38, v38
  v_rcp_f32 v39, v39
  ds_write_b64 v9, v[56:57] offset:1088
  global_load_dwordx4 v[232:235], v3, s[80:81] offset:2048 sc1
  v_rcp_f32 v40, v40
  v_rcp_f32 v41, v41
  v_rcp_f32 v42, v42
  v_rcp_f32 v43, v43
  ds_write_b64 v9, v[58:59] offset:1632
  v_pk_mul_f32 v[36:37], v[20:21], v[36:37]
  v_pk_mul_f32 v[38:39], v[22:23], v[38:39]
  v_pk_mul_f32 v[40:41], v[24:25], v[40:41]
  v_pk_mul_f32 v[42:43], v[26:27], v[42:43]
  v_pk_mul_f32 v[44:45], v[28:29], v[28:29]
  global_load_dwordx4 v[236:239], v3, s[80:81] offset:3072 sc1
  v_pk_mul_f32 v[46:47], v[30:31], v[30:31]
  v_pk_mul_f32 v[48:49], v[32:33], v[32:33]
  v_pk_mul_f32 v[50:51], v[34:35], v[34:35]
  v_pk_fma_f32 v[44:45], v[44:45], s[64:65], v[12:13]
  v_pk_fma_f32 v[46:47], v[46:47], s[64:65], v[12:13]
  v_pk_fma_f32 v[48:49], v[48:49], s[64:65], v[12:13]
  v_pk_fma_f32 v[50:51], v[50:51], s[64:65], v[12:13]
  v_pk_mul_f32 v[44:45], v[28:29], v[44:45]
  v_pk_mul_f32 v[46:47], v[30:31], v[46:47]
  v_pk_mul_f32 v[48:49], v[32:33], v[48:49]
  v_pk_mul_f32 v[50:51], v[34:35], v[50:51]
  v_exp_f32 v44, v44
  v_exp_f32 v45, v45
  v_add_u32 v3, 0x8c000, v2
  global_load_dwordx4 v[240:243], v3, s[80:81] offset:0 sc1
  v_exp_f32 v46, v46
  v_exp_f32 v47, v47
  v_exp_f32 v48, v48
  v_exp_f32 v49, v49
  v_exp_f32 v50, v50
  v_exp_f32 v51, v51
  v_pk_add_f32 v[44:45], v[44:45], s[66:67]
  v_pk_add_f32 v[46:47], v[46:47], s[66:67]
  global_load_dwordx4 v[244:247], v3, s[80:81] offset:1024 sc1
  v_pk_add_f32 v[48:49], v[48:49], s[66:67]
  v_pk_add_f32 v[50:51], v[50:51], s[66:67]
  v_rcp_f32 v44, v44
  v_rcp_f32 v45, v45
  v_rcp_f32 v46, v46
  v_rcp_f32 v47, v47
  v_rcp_f32 v48, v48
  v_rcp_f32 v49, v49
  global_load_dwordx4 v[248:251], v3, s[80:81] offset:2048 sc1
  v_rcp_f32 v50, v50
  v_rcp_f32 v51, v51
  v_pk_mul_f32 v[44:45], v[28:29], v[44:45]
  v_pk_mul_f32 v[46:47], v[30:31], v[46:47]
  v_pk_mul_f32 v[48:49], v[32:33], v[48:49]
  v_pk_mul_f32 v[50:51], v[34:35], v[50:51]
  v_cvt_pk_bf16_f32 v52, v36, v40
  v_cvt_pk_bf16_f32 v53, v44, v48
  v_cvt_pk_bf16_f32 v54, v37, v41
  v_cvt_pk_bf16_f32 v55, v45, v49
  v_cvt_pk_bf16_f32 v56, v38, v42
  v_cvt_pk_bf16_f32 v57, v46, v50
  global_load_dwordx4 v[252:255], v3, s[80:81] offset:3072 sc1
  v_cvt_pk_bf16_f32 v58, v39, v43
  v_cvt_pk_bf16_f32 v59, v47, v51
  ds_write_b64 v9, v[52:53] offset:8704
  ds_write_b64 v9, v[54:55] offset:9248
  ds_write_b64 v9, v[56:57] offset:9792
  ds_write_b64 v9, v[58:59] offset:10336
  s_waitcnt lgkmcnt(0)
  s_barrier
  s_lshl_b32 s95, s56, 11
  s_add_u32 m0, s95, 40960
  s_mov_b32 s94, 40960
  buffer_load_dwordx4 v18, s[88:91], s94 offen sc1 lds
  ds_read_b128 a[0:3], v5 offset:0
  ds_read_b128 a[4:7], v5 offset:8704
  s_waitcnt vmcnt(29)
  s_waitcnt lgkmcnt(0)
  v_mfma_f32_16x16x32_bf16 a[32:35], a[0:3], v[128:131], a[32:35]
  ds_read_b128 a[8:11], v5 offset:64
  v_mfma_f32_16x16x32_bf16 a[48:51], a[4:7], v[128:131], a[48:51]
  ds_read_b128 a[12:15], v5 offset:8768
  v_mfma_f32_16x16x32_bf16 a[36:39], a[0:3], v[132:135], a[36:39]
  v_mfma_f32_16x16x32_bf16 a[52:55], a[4:7], v[132:135], a[52:55]
  s_lshl_b32 s95, s56, 11
  s_add_u32 m0, s95, 41984
  s_mov_b32 s94, 41984
  buffer_load_dwordx4 v18, s[88:91], s94 offen sc1 lds
  v_mfma_f32_16x16x32_bf16 a[40:43], a[0:3], v[136:139], a[40:43]
  v_mfma_f32_16x16x32_bf16 a[56:59], a[4:7], v[136:139], a[56:59]
  v_mfma_f32_16x16x32_bf16 a[44:47], a[0:3], v[140:143], a[44:47]
  v_mfma_f32_16x16x32_bf16 a[60:63], a[4:7], v[140:143], a[60:63]
  s_waitcnt vmcnt(26)
  s_waitcnt lgkmcnt(0)
  v_mfma_f32_16x16x32_bf16 a[32:35], a[8:11], v[144:147], a[32:35]
  ds_read_b128 a[0:3], v5 offset:128
  s_lshl_b32 s95, s56, 11
  s_add_u32 m0, s95, 49152
  s_mov_b32 s94, 49152
  buffer_load_dwordx4 v18, s[88:91], s94 offen sc1 lds
  v_mfma_f32_16x16x32_bf16 a[48:51], a[12:15], v[144:147], a[48:51]
  ds_read_b128 a[4:7], v5 offset:8832
  v_mfma_f32_16x16x32_bf16 a[36:39], a[8:11], v[148:151], a[36:39]
  v_mfma_f32_16x16x32_bf16 a[52:55], a[12:15], v[148:151], a[52:55]
  v_mfma_f32_16x16x32_bf16 a[40:43], a[8:11], v[152:155], a[40:43]
  v_mfma_f32_16x16x32_bf16 a[56:59], a[12:15], v[152:155], a[56:59]
  v_mfma_f32_16x16x32_bf16 a[44:47], a[8:11], v[156:159], a[44:47]
  s_lshl_b32 s95, s56, 11
  s_add_u32 m0, s95, 50176
  s_mov_b32 s94, 50176
  buffer_load_dwordx4 v18, s[88:91], s94 offen sc1 lds
  v_mfma_f32_16x16x32_bf16 a[60:63], a[12:15], v[156:159], a[60:63]
  s_waitcnt vmcnt(24)
  s_waitcnt lgkmcnt(0)
  v_mfma_f32_16x16x32_bf16 a[32:35], a[0:3], v[160:163], a[32:35]
  ds_read_b128 a[8:11], v5 offset:192
  v_mfma_f32_16x16x32_bf16 a[48:51], a[4:7], v[160:163], a[48:51]
  ds_read_b128 a[12:15], v5 offset:8896
  v_mfma_f32_16x16x32_bf16 a[36:39], a[0:3], v[164:167], a[36:39]
  v_mfma_f32_16x16x32_bf16 a[52:55], a[4:7], v[164:167], a[52:55]
  s_lshl_b32 s95, s56, 11
  s_add_u32 m0, s95, 57344
  s_mov_b32 s94, 57344
  buffer_load_dwordx4 v18, s[88:91], s94 offen sc1 lds
  v_mfma_f32_16x16x32_bf16 a[40:43], a[0:3], v[168:171], a[40:43]
  v_mfma_f32_16x16x32_bf16 a[56:59], a[4:7], v[168:171], a[56:59]
  v_mfma_f32_16x16x32_bf16 a[44:47], a[0:3], v[172:175], a[44:47]
  v_mfma_f32_16x16x32_bf16 a[60:63], a[4:7], v[172:175], a[60:63]
  s_waitcnt vmcnt(21)
  s_waitcnt lgkmcnt(0)
  v_mfma_f32_16x16x32_bf16 a[32:35], a[8:11], v[176:179], a[32:35]
  ds_read_b128 a[0:3], v5 offset:256
  s_lshl_b32 s95, s56, 11
  s_add_u32 m0, s95, 58368
  s_mov_b32 s94, 58368
  buffer_load_dwordx4 v18, s[88:91], s94 offen sc1 lds
  v_mfma_f32_16x16x32_bf16 a[48:51], a[12:15], v[176:179], a[48:51]
  ds_read_b128 a[4:7], v5 offset:8960
  v_mfma_f32_16x16x32_bf16 a[36:39], a[8:11], v[180:183], a[36:39]
  v_mfma_f32_16x16x32_bf16 a[52:55], a[12:15], v[180:183], a[52:55]
  v_mfma_f32_16x16x32_bf16 a[40:43], a[8:11], v[184:187], a[40:43]
  v_mfma_f32_16x16x32_bf16 a[56:59], a[12:15], v[184:187], a[56:59]
  v_mfma_f32_16x16x32_bf16 a[44:47], a[8:11], v[188:191], a[44:47]
  s_lshl_b32 s95, s56, 11
  s_add_u32 m0, s95, 65536
  s_mov_b32 s94, 65536
  buffer_load_dwordx4 v18, s[88:91], s94 offen sc1 lds
  v_mfma_f32_16x16x32_bf16 a[60:63], a[12:15], v[188:191], a[60:63]
  s_waitcnt vmcnt(19)
  s_waitcnt lgkmcnt(0)
  v_mfma_f32_16x16x32_bf16 a[32:35], a[0:3], v[192:195], a[32:35]
  ds_read_b128 a[8:11], v5 offset:320
  v_mfma_f32_16x16x32_bf16 a[48:51], a[4:7], v[192:195], a[48:51]
  ds_read_b128 a[12:15], v5 offset:9024
  v_mfma_f32_16x16x32_bf16 a[36:39], a[0:3], v[196:199], a[36:39]
  v_mfma_f32_16x16x32_bf16 a[52:55], a[4:7], v[196:199], a[52:55]
  s_lshl_b32 s95, s56, 11
  s_add_u32 m0, s95, 66560
  s_mov_b32 s94, 66560
  buffer_load_dwordx4 v18, s[88:91], s94 offen sc1 lds
  v_mfma_f32_16x16x32_bf16 a[40:43], a[0:3], v[200:203], a[40:43]
  v_mfma_f32_16x16x32_bf16 a[56:59], a[4:7], v[200:203], a[56:59]
  v_mfma_f32_16x16x32_bf16 a[44:47], a[0:3], v[204:207], a[44:47]
  v_mfma_f32_16x16x32_bf16 a[60:63], a[4:7], v[204:207], a[60:63]
  s_waitcnt vmcnt(16)
  s_waitcnt lgkmcnt(0)
  v_mfma_f32_16x16x32_bf16 a[32:35], a[8:11], v[208:211], a[32:35]
  ds_read_b128 a[0:3], v5 offset:384
  s_lshl_b32 s95, s56, 11
  s_add_u32 m0, s95, 73728
  s_mov_b32 s94, 73728
  buffer_load_dwordx4 v18, s[88:91], s94 offen sc1 lds
  v_mfma_f32_16x16x32_bf16 a[48:51], a[12:15], v[208:211], a[48:51]
  ds_read_b128 a[4:7], v5 offset:9088
  v_mfma_f32_16x16x32_bf16 a[36:39], a[8:11], v[212:215], a[36:39]
  v_mfma_f32_16x16x32_bf16 a[52:55], a[12:15], v[212:215], a[52:55]
  v_mfma_f32_16x16x32_bf16 a[40:43], a[8:11], v[216:219], a[40:43]
  v_mfma_f32_16x16x32_bf16 a[56:59], a[12:15], v[216:219], a[56:59]
  v_mfma_f32_16x16x32_bf16 a[44:47], a[8:11], v[220:223], a[44:47]
  s_lshl_b32 s95, s56, 11
  s_add_u32 m0, s95, 74752
  s_mov_b32 s94, 74752
  buffer_load_dwordx4 v18, s[88:91], s94 offen sc1 lds
  v_mfma_f32_16x16x32_bf16 a[60:63], a[12:15], v[220:223], a[60:63]
  s_waitcnt vmcnt(14)
  s_waitcnt lgkmcnt(0)
  v_mfma_f32_16x16x32_bf16 a[32:35], a[0:3], v[224:227], a[32:35]
  ds_read_b128 a[8:11], v5 offset:448
  v_mfma_f32_16x16x32_bf16 a[48:51], a[4:7], v[224:227], a[48:51]
  ds_read_b128 a[12:15], v5 offset:9152
  v_mfma_f32_16x16x32_bf16 a[36:39], a[0:3], v[228:231], a[36:39]
  v_mfma_f32_16x16x32_bf16 a[52:55], a[4:7], v[228:231], a[52:55]
  s_lshl_b32 s95, s56, 11
  s_add_u32 m0, s95, 81920
  s_mov_b32 s94, 81920
  buffer_load_dwordx4 v18, s[88:91], s94 offen sc1 lds
  v_mfma_f32_16x16x32_bf16 a[40:43], a[0:3], v[232:235], a[40:43]
  v_mfma_f32_16x16x32_bf16 a[56:59], a[4:7], v[232:235], a[56:59]
  v_mfma_f32_16x16x32_bf16 a[44:47], a[0:3], v[236:239], a[44:47]
  v_mfma_f32_16x16x32_bf16 a[60:63], a[4:7], v[236:239], a[60:63]
  s_waitcnt vmcnt(11)
  s_waitcnt lgkmcnt(0)
  v_mfma_f32_16x16x32_bf16 a[32:35], a[8:11], v[240:243], a[32:35]
  v_mfma_f32_16x16x32_bf16 a[48:51], a[12:15], v[240:243], a[48:51]
  s_lshl_b32 s95, s56, 11
  s_add_u32 m0, s95, 82944
  s_mov_b32 s94, 82944
  buffer_load_dwordx4 v18, s[88:91], s94 offen sc1 lds
  v_mfma_f32_16x16x32_bf16 a[36:39], a[8:11], v[244:247], a[36:39]
  v_mfma_f32_16x16x32_bf16 a[52:55], a[12:15], v[244:247], a[52:55]
  v_mfma_f32_16x16x32_bf16 a[40:43], a[8:11], v[248:251], a[40:43]
  v_mfma_f32_16x16x32_bf16 a[56:59], a[12:15], v[248:251], a[56:59]
  v_mfma_f32_16x16x32_bf16 a[44:47], a[8:11], v[252:255], a[44:47]
  v_mfma_f32_16x16x32_bf16 a[60:63], a[12:15], v[252:255], a[60:63]
  s_lshl_b32 s95, s56, 11
  s_add_u32 m0, s95, 90112
  s_mov_b32 s94, 90112
  buffer_load_dwordx4 v18, s[88:91], s94 offen sc1 lds
  v_lshrrev_b32 v16, 4, v14
  v_and_b32 v17, 15, v14
  s_lshl_b32 s69, s58, 9
  s_lshl_b32 s70, s57, 4
  s_add_u32 s69, s69, s70
  s_add_u32 s69, s69, 122368
  v_mul_u32_u24 v16, 4160, v16
  v_lshl_add_u32 v16, v17, 5, v16
  v_add_u32 v9, s69, v16
  v_mov_b32 v10, 0
  s_nop 4
  v_accvgpr_read_b32 v20, a32
  s_lshl_b32 s95, s56, 11
  s_add_u32 m0, s95, 91136
  s_mov_b32 s94, 91136
  buffer_load_dwordx4 v18, s[88:91], s94 offen sc1 lds
  v_accvgpr_read_b32 v21, a33
  v_accvgpr_read_b32 v22, a34
  v_accvgpr_read_b32 v23, a35
  v_accvgpr_read_b32 v24, a36
  v_accvgpr_read_b32 v25, a37
  v_accvgpr_read_b32 v26, a38
  v_accvgpr_read_b32 v27, a39
  v_accvgpr_read_b32 v28, a40
  v_accvgpr_read_b32 v29, a41
  v_accvgpr_read_b32 v30, a42
  v_accvgpr_read_b32 v31, a43
  v_accvgpr_read_b32 v32, a44
  v_accvgpr_read_b32 v33, a45
  v_accvgpr_read_b32 v34, a46
  s_lshl_b32 s95, s56, 11
  s_add_u32 m0, s95, 98304
  s_mov_b32 s94, 98304
  buffer_load_dwordx4 v18, s[88:91], s94 offen sc1 lds
  v_accvgpr_read_b32 v35, a47
  v_cvt_pk_bf16_f32 v36, v20, v21
  v_cvt_pk_bf16_f32 v37, v22, v23
  v_cvt_pk_bf16_f32 v38, v24, v25
  v_cvt_pk_bf16_f32 v39, v26, v27
  v_cvt_pk_bf16_f32 v40, v28, v29
  v_cvt_pk_bf16_f32 v41, v30, v31
  v_cvt_pk_bf16_f32 v42, v32, v33
  v_cvt_pk_bf16_f32 v43, v34, v35
  v_lshlrev_b32 v20, 16, v36
  v_and_b32 v21, 0xffff0000, v36
  v_lshlrev_b32 v22, 16, v37
  v_and_b32 v23, 0xffff0000, v37
  v_lshlrev_b32 v24, 16, v38
  s_lshl_b32 s95, s56, 11
  s_add_u32 m0, s95, 99328
  s_mov_b32 s94, 99328
  buffer_load_dwordx4 v18, s[88:91], s94 offen sc1 lds
  v_and_b32 v25, 0xffff0000, v38
  v_lshlrev_b32 v26, 16, v39
  v_and_b32 v27, 0xffff0000, v39
  v_lshlrev_b32 v28, 16, v40
  v_and_b32 v29, 0xffff0000, v40
  v_lshlrev_b32 v30, 16, v41
  v_and_b32 v31, 0xffff0000, v41
  v_lshlrev_b32 v32, 16, v42
  v_and_b32 v33, 0xffff0000, v42
  v_lshlrev_b32 v34, 16, v43
  v_and_b32 v35, 0xffff0000, v43
  v_mul_f32 v20, s76, v20
  v_mul_f32 v21, s76, v21
  v_mul_f32 v22, s76, v22
  s_lshl_b32 s95, s56, 11
  s_add_u32 m0, s95, 106496
  s_mov_b32 s94, 106496
  buffer_load_dwordx4 v18, s[88:91], s94 offen sc1 lds
  v_mul_f32 v23, s76, v23
  v_mul_f32 v24, s76, v24
  v_mul_f32 v25, s76, v25
  v_mul_f32 v26, s76, v26
  v_mul_f32 v27, s76, v27
  v_mul_f32 v28, s76, v28
  v_mul_f32 v29, s76, v29
  v_mul_f32 v30, s76, v30
  v_mul_f32 v31, s76, v31
  v_mul_f32 v32, s76, v32
  v_mul_f32 v33, s76, v33
  v_mul_f32 v34, s76, v34
  v_mul_f32 v35, s76, v35
  v_max3_f32 v10, |v20|, |v21|, v10
  s_lshl_b32 s95, s56, 11
  s_add_u32 m0, s95, 107520
  s_mov_b32 s94, 107520
  buffer_load_dwordx4 v18, s[88:91], s94 offen sc1 lds
  v_max3_f32 v10, |v22|, |v23|, v10
  v_max3_f32 v10, |v24|, |v25|, v10
  v_max3_f32 v10, |v26|, |v27|, v10
  v_max3_f32 v10, |v28|, |v29|, v10
  v_max3_f32 v10, |v30|, |v31|, v10
  v_max3_f32 v10, |v32|, |v33|, v10
  v_max3_f32 v10, |v34|, |v35|, v10
  v_exp_f32 v44, v20
  v_exp_f32 v48, v21
  v_exp_f32 v52, v22
  v_exp_f32 v56, v23
  v_lshlrev_b32 v3, 4, v14
  v_add_u32 v3, 0xac000, v3
  global_load_dwordx4 a[192:195], v3, s[80:81] offset:0 sc1
  v_exp_f32 v45, v24
  v_exp_f32 v49, v25
  v_exp_f32 v53, v26
  v_exp_f32 v57, v27
  v_exp_f32 v46, v28
  v_exp_f32 v50, v29
  v_exp_f32 v54, v30
  global_load_dwordx4 a[196:199], v3, s[80:81] offset:1024 sc1
  v_exp_f32 v58, v31
  v_exp_f32 v47, v32
  v_exp_f32 v51, v33
  v_exp_f32 v55, v34
  v_exp_f32 v59, v35
  s_barrier
  global_load_dwordx4 a[200:203], v3, s[80:81] offset:2048 sc1
  s_nop 0
  ds_write_b128 v9, v[44:47] offset:0
  ds_write_b128 v9, v[48:51] offset:1040
  ds_write_b128 v9, v[52:55] offset:2080
  ds_write_b128 v9, v[56:59] offset:3120
  v_accvgpr_read_b32 v20, a48
  global_load_dwordx4 a[204:207], v3, s[80:81] offset:3072 sc1
  v_accvgpr_read_b32 v21, a49
  v_accvgpr_read_b32 v22, a50
  v_accvgpr_read_b32 v23, a51
  v_accvgpr_read_b32 v24, a52
  v_accvgpr_read_b32 v25, a53
  v_accvgpr_read_b32 v26, a54
  v_accvgpr_read_b32 v27, a55
  v_accvgpr_read_b32 v28, a56
  v_accvgpr_read_b32 v29, a57
  v_accvgpr_read_b32 v30, a58
  v_accvgpr_read_b32 v31, a59
  v_accvgpr_read_b32 v32, a60
  v_accvgpr_read_b32 v33, a61
  v_accvgpr_read_b32 v34, a62
  v_lshlrev_b32 v3, 4, v14
  v_add_u32 v3, 0xad000, v3
  global_load_dwordx4 a[208:211], v3, s[80:81] offset:0 sc1
  v_accvgpr_read_b32 v35, a63
  v_cvt_pk_bf16_f32 v36, v20, v21
  v_cvt_pk_bf16_f32 v37, v22, v23
  v_cvt_pk_bf16_f32 v38, v24, v25
  v_cvt_pk_bf16_f32 v39, v26, v27
  v_cvt_pk_bf16_f32 v40, v28, v29
  v_cvt_pk_bf16_f32 v41, v30, v31
  v_cvt_pk_bf16_f32 v42, v32, v33
  v_cvt_pk_bf16_f32 v43, v34, v35
  v_lshlrev_b32 v20, 16, v36
  v_and_b32 v21, 0xffff0000, v36
  v_lshlrev_b32 v22, 16, v37
  v_and_b32 v23, 0xffff0000, v37
  v_lshlrev_b32 v24, 16, v38
  global_load_dwordx4 a[212:215], v3, s[80:81] offset:1024 sc1
  v_and_b32 v25, 0xffff0000, v38
  v_lshlrev_b32 v26, 16, v39
  v_and_b32 v27, 0xffff0000, v39
  v_lshlrev_b32 v28, 16, v40
  v_and_b32 v29, 0xffff0000, v40
  v_lshlrev_b32 v30, 16, v41
  v_and_b32 v31, 0xffff0000, v41
  v_lshlrev_b32 v32, 16, v42
  v_and_b32 v33, 0xffff0000, v42
  v_lshlrev_b32 v34, 16, v43
  v_and_b32 v35, 0xffff0000, v43
  v_mul_f32 v20, s76, v20
  v_mul_f32 v21, s76, v21
  v_mul_f32 v22, s76, v22
  global_load_dwordx4 a[216:219], v3, s[80:81] offset:2048 sc1
  v_mul_f32 v23, s76, v23
  v_mul_f32 v24, s76, v24
  v_mul_f32 v25, s76, v25
  v_mul_f32 v26, s76, v26
  v_mul_f32 v27, s76, v27
  v_mul_f32 v28, s76, v28
  v_mul_f32 v29, s76, v29
  v_mul_f32 v30, s76, v30
  v_mul_f32 v31, s76, v31
  v_mul_f32 v32, s76, v32
  v_mul_f32 v33, s76, v33
  v_mul_f32 v34, s76, v34
  v_mul_f32 v35, s76, v35
  v_max3_f32 v10, |v20|, |v21|, v10
  global_load_dwordx4 a[220:223], v3, s[80:81] offset:3072 sc1
  v_max3_f32 v10, |v22|, |v23|, v10
  v_max3_f32 v10, |v24|, |v25|, v10
  v_max3_f32 v10, |v26|, |v27|, v10
  v_max3_f32 v10, |v28|, |v29|, v10
  v_max3_f32 v10, |v30|, |v31|, v10
  v_max3_f32 v10, |v32|, |v33|, v10
  v_max3_f32 v10, |v34|, |v35|, v10
  v_exp_f32 v44, v20
  v_exp_f32 v48, v21
  v_exp_f32 v52, v22
  v_exp_f32 v56, v23
  v_lshlrev_b32 v3, 4, v14
  v_add_u32 v3, 0xae000, v3
  global_load_dwordx4 a[224:227], v3, s[80:81] offset:0 sc1
  v_exp_f32 v45, v24
  v_exp_f32 v49, v25
  v_exp_f32 v53, v26
  v_exp_f32 v57, v27
  v_exp_f32 v46, v28
  v_exp_f32 v50, v29
  v_exp_f32 v54, v30
  global_load_dwordx4 a[228:231], v3, s[80:81] offset:1024 sc1
  v_exp_f32 v58, v31
  v_exp_f32 v47, v32
  v_exp_f32 v51, v33
  v_exp_f32 v55, v34
  v_exp_f32 v59, v35
  s_nop 0
  ds_write_b128 v9, v[44:47] offset:16640
  global_load_dwordx4 a[232:235], v3, s[80:81] offset:2048 sc1
  ds_write_b128 v9, v[48:51] offset:17680
  ds_write_b128 v9, v[52:55] offset:18720
  ds_write_b128 v9, v[56:59] offset:19760
  v_mov_b32 v16, 0x42fa0000
  v_cmp_nle_f32 vcc, v10, v16
  s_lshl_b32 s69, s56, 2
  s_add_u32 s69, s69, 114688
  s_or_b32 s68, s68, vcc_lo
  s_or_b32 s68, s68, vcc_hi
  v_mov_b32 v16, s69
  global_load_dwordx4 a[236:239], v3, s[80:81] offset:3072 sc1
  v_mov_b32 v17, s68
  ds_write_b32 v16, v17
  v_mov_b32 v60, 0
  v_mov_b32 v61, 0
  v_mov_b32 v62, 0
  v_mov_b32 v63, 0
  v_lshlrev_b32 v3, 4, v14
  v_add_u32 v3, 0xaf000, v3
  global_load_dwordx4 a[240:243], v3, s[80:81] offset:0 sc1
  global_load_dwordx4 a[244:247], v3, s[80:81] offset:1024 sc1
  global_load_dwordx4 a[248:251], v3, s[80:81] offset:2048 sc1
  global_load_dwordx4 a[252:255], v3, s[80:81] offset:3072 sc1
  s_lshl_b32 s95, s56, 11
  s_add_u32 m0, s95, 0
  s_mov_b32 s94, 0
  buffer_load_dwordx4 v18, s[88:91], s94 offen sc1 lds
  s_lshl_b32 s95, s56, 11
  s_add_u32 m0, s95, 1024
  s_mov_b32 s94, 1024
  buffer_load_dwordx4 v18, s[88:91], s94 offen sc1 lds
  s_lshl_b32 s95, s56, 11
  s_add_u32 m0, s95, 8192
  s_mov_b32 s94, 8192
  buffer_load_dwordx4 v18, s[88:91], s94 offen sc1 lds
  s_lshl_b32 s95, s56, 11
  s_add_u32 m0, s95, 9216
  s_mov_b32 s94, 9216
  buffer_load_dwordx4 v18, s[88:91], s94 offen sc1 lds
  s_lshl_b32 s95, s56, 11
  s_add_u32 m0, s95, 16384
  s_mov_b32 s94, 16384
  buffer_load_dwordx4 v18, s[88:91], s94 offen sc1 lds
  s_lshl_b32 s95, s56, 11
  s_add_u32 m0, s95, 17408
  s_mov_b32 s94, 17408
  buffer_load_dwordx4 v18, s[88:91], s94 offen sc1 lds
  s_lshl_b32 s95, s56, 11
  s_add_u32 m0, s95, 24576
  s_mov_b32 s94, 24576
  buffer_load_dwordx4 v18, s[88:91], s94 offen sc1 lds
  s_lshl_b32 s95, s56, 11
  s_add_u32 m0, s95, 25600
  s_mov_b32 s94, 25600
  buffer_load_dwordx4 v18, s[88:91], s94 offen sc1 lds
  s_lshl_b32 s95, s56, 11
  s_add_u32 m0, s95, 32768
  s_mov_b32 s94, 32768
  buffer_load_dwordx4 v18, s[88:91], s94 offen sc1 lds
  s_lshl_b32 s95, s56, 11
  s_add_u32 m0, s95, 33792
  s_mov_b32 s94, 33792
  buffer_load_dwordx4 v18, s[88:91], s94 offen sc1 lds
  s_nop 1
  v_mfma_f32_32x32x16_bf16 v[64:79], v[60:63], v[60:63], 0
  v_mfma_f32_32x32x16_bf16 v[80:95], v[60:63], v[60:63], 0
  v_mfma_f32_32x32x16_bf16 v[96:111], v[60:63], v[60:63], 0
  v_mfma_f32_32x32x16_bf16 v[112:127], v[60:63], v[60:63], 0
  v_mfma_f32_32x32x16_bf16 v[128:143], v[60:63], v[60:63], 0
  v_mfma_f32_32x32x16_bf16 v[144:159], v[60:63], v[60:63], 0
  v_mfma_f32_32x32x16_bf16 v[160:175], v[60:63], v[60:63], 0
  v_mfma_f32_32x32x16_bf16 v[176:191], v[60:63], v[60:63], 0
  v_mfma_f32_32x32x16_bf16 a[64:79], v[60:63], v[60:63], 0
  v_mfma_f32_32x32x16_bf16 a[80:95], v[60:63], v[60:63], 0
  v_mfma_f32_32x32x16_bf16 a[96:111], v[60:63], v[60:63], 0
  v_mfma_f32_32x32x16_bf16 a[112:127], v[60:63], v[60:63], 0
  v_mfma_f32_32x32x16_bf16 a[128:143], v[60:63], v[60:63], 0
  v_mfma_f32_32x32x16_bf16 a[144:159], v[60:63], v[60:63], 0
  v_mfma_f32_32x32x16_bf16 a[160:175], v[60:63], v[60:63], 0
  v_mfma_f32_32x32x16_bf16 a[176:191], v[60:63], v[60:63], 0
  s_waitcnt vmcnt(0) lgkmcnt(0)
  s_barrier
  v_mov_b32 v16, 0x1c000
  ds_read_b128 v[20:23], v16
  s_waitcnt lgkmcnt(0)
  v_or3_b32 v16, v20, v21, v22
  v_or_b32 v16, v16, v23
  s_nop 0
  v_readfirstlane_b32 s68, v16
  s_nop 3
  s_cmp_eq_u32 s68, 0
  s_cbranch_scc1 L_fast1
  v_accvgpr_read_b32 v20, a32
  v_accvgpr_read_b32 v21, a33
  v_accvgpr_read_b32 v22, a34
  v_accvgpr_read_b32 v23, a35
  v_accvgpr_read_b32 v24, a36
  v_accvgpr_read_b32 v25, a37
  v_accvgpr_read_b32 v26, a38
  v_accvgpr_read_b32 v27, a39
  v_accvgpr_read_b32 v28, a40
  v_accvgpr_read_b32 v29, a41
  v_accvgpr_read_b32 v30, a42
  v_accvgpr_read_b32 v31, a43
  v_accvgpr_read_b32 v32, a44
  v_accvgpr_read_b32 v33, a45
  v_accvgpr_read_b32 v34, a46
  v_accvgpr_read_b32 v35, a47
  v_cvt_pk_bf16_f32 v36, v20, v21
  v_cvt_pk_bf16_f32 v37, v22, v23
  v_cvt_pk_bf16_f32 v38, v24, v25
  v_cvt_pk_bf16_f32 v39, v26, v27
  v_cvt_pk_bf16_f32 v40, v28, v29
  v_cvt_pk_bf16_f32 v41, v30, v31
  v_cvt_pk_bf16_f32 v42, v32, v33
  v_cvt_pk_bf16_f32 v43, v34, v35
  v_lshlrev_b32 v20, 16, v36
  v_and_b32 v21, 0xffff0000, v36
  v_lshlrev_b32 v22, 16, v37
  v_and_b32 v23, 0xffff0000, v37
  v_lshlrev_b32 v24, 16, v38
  v_and_b32 v25, 0xffff0000, v38
  v_lshlrev_b32 v26, 16, v39
  v_and_b32 v27, 0xffff0000, v39
  v_lshlrev_b32 v28, 16, v40
  v_and_b32 v29, 0xffff0000, v40
  v_lshlrev_b32 v30, 16, v41
  v_and_b32 v31, 0xffff0000, v41
  v_lshlrev_b32 v32, 16, v42
  v_and_b32 v33, 0xffff0000, v42
  v_lshlrev_b32 v34, 16, v43
  v_and_b32 v35, 0xffff0000, v43
  v_mul_f32 v20, s76, v20
  v_mul_f32 v21, s76, v21
  v_mul_f32 v22, s76, v22
  v_mul_f32 v23, s76, v23
  v_mul_f32 v24, s76, v24
  v_mul_f32 v25, s76, v25
  v_mul_f32 v26, s76, v26
  v_mul_f32 v27, s76, v27
  v_mul_f32 v28, s76, v28
  v_mul_f32 v29, s76, v29
  v_mul_f32 v30, s76, v30
  v_mul_f32 v31, s76, v31
  v_mul_f32 v32, s76, v32
  v_mul_f32 v33, s76, v33
  v_mul_f32 v34, s76, v34
  v_mul_f32 v35, s76, v35
  v_mov_b32 v44, v20
  v_mov_b32 v48, v21
  v_mov_b32 v52, v22
  v_mov_b32 v56, v23
  v_mov_b32 v45, v24
  v_mov_b32 v49, v25
  v_mov_b32 v53, v26
  v_mov_b32 v57, v27
  v_mov_b32 v46, v28
  v_mov_b32 v50, v29
  v_mov_b32 v54, v30
  v_mov_b32 v58, v31
  v_mov_b32 v47, v32
  v_mov_b32 v51, v33
  v_mov_b32 v55, v34
  v_mov_b32 v59, v35
  s_nop 0
  ds_write_b128 v9, v[44:47] offset:0
  ds_write_b128 v9, v[48:51] offset:1040
  ds_write_b128 v9, v[52:55] offset:2080
  ds_write_b128 v9, v[56:59] offset:3120
  v_accvgpr_read_b32 v20, a48
  v_accvgpr_read_b32 v21, a49
  v_accvgpr_read_b32 v22, a50
  v_accvgpr_read_b32 v23, a51
  v_accvgpr_read_b32 v24, a52
  v_accvgpr_read_b32 v25, a53
  v_accvgpr_read_b32 v26, a54
  v_accvgpr_read_b32 v27, a55
  v_accvgpr_read_b32 v28, a56
  v_accvgpr_read_b32 v29, a57
  v_accvgpr_read_b32 v30, a58
  v_accvgpr_read_b32 v31, a59
  v_accvgpr_read_b32 v32, a60
  v_accvgpr_read_b32 v33, a61
  v_accvgpr_read_b32 v34, a62
  v_accvgpr_read_b32 v35, a63
  v_cvt_pk_bf16_f32 v36, v20, v21
  v_cvt_pk_bf16_f32 v37, v22, v23
  v_cvt_pk_bf16_f32 v38, v24, v25
  v_cvt_pk_bf16_f32 v39, v26, v27
  v_cvt_pk_bf16_f32 v40, v28, v29
  v_cvt_pk_bf16_f32 v41, v30, v31
  v_cvt_pk_bf16_f32 v42, v32, v33
  v_cvt_pk_bf16_f32 v43, v34, v35
  v_lshlrev_b32 v20, 16, v36
  v_and_b32 v21, 0xffff0000, v36
  v_lshlrev_b32 v22, 16, v37
  v_and_b32 v23, 0xffff0000, v37
  v_lshlrev_b32 v24, 16, v38
  v_and_b32 v25, 0xffff0000, v38
  v_lshlrev_b32 v26, 16, v39
  v_and_b32 v27, 0xffff0000, v39
  v_lshlrev_b32 v28, 16, v40
  v_and_b32 v29, 0xffff0000, v40
  v_lshlrev_b32 v30, 16, v41
  v_and_b32 v31, 0xffff0000, v41
  v_lshlrev_b32 v32, 16, v42
  v_and_b32 v33, 0xffff0000, v42
  v_lshlrev_b32 v34, 16, v43
  v_and_b32 v35, 0xffff0000, v43
  v_mul_f32 v20, s76, v20
  v_mul_f32 v21, s76, v21
  v_mul_f32 v22, s76, v22
  v_mul_f32 v23, s76, v23
  v_mul_f32 v24, s76, v24
  v_mul_f32 v25, s76, v25
  v_mul_f32 v26, s76, v26
  v_mul_f32 v27, s76, v27
  v_mul_f32 v28, s76, v28
  v_mul_f32 v29, s76, v29
  v_mul_f32 v30, s76, v30
  v_mul_f32 v31, s76, v31
  v_mul_f32 v32, s76, v32
  v_mul_f32 v33, s76, v33
  v_mul_f32 v34, s76, v34
  v_mul_f32 v35, s76, v35
  v_mov_b32 v44, v20
  v_mov_b32 v48, v21
  v_mov_b32 v52, v22
  v_mov_b32 v56, v23
  v_mov_b32 v45, v24
  v_mov_b32 v49, v25
  v_mov_b32 v53, v26
  v_mov_b32 v57, v27
  v_mov_b32 v46, v28
  v_mov_b32 v50, v29
  v_mov_b32 v54, v30
  v_mov_b32 v58, v31
  v_mov_b32 v47, v32
  v_mov_b32 v51, v33
  v_mov_b32 v55, v34
  v_mov_b32 v59, v35
  s_nop 0
  ds_write_b128 v9, v[44:47] offset:16640
  ds_write_b128 v9, v[48:51] offset:17680
  ds_write_b128 v9, v[52:55] offset:18720
  ds_write_b128 v9, v[56:59] offset:19760
  s_lshl_b32 s69, s59, 14
  s_lshl_b32 s70, s56, 11
  s_add_u32 s69, s69, s70
  s_add_u32 s69, s69, 8192
  v_lshlrev_b32 v16, 4, v14
  v_add_u32 v16, s69, v16
  s_add_u32 s70, s70, 155648
  s_mov_b32 m0, s70
  s_nop 0
  buffer_load_dwordx4 v16, s[88:91], 0 offen sc0 sc1 lds
  buffer_load_dwordx4 v16, s[88:91], 0 offen offset:1024 sc0 sc1 lds
  s_waitcnt vmcnt(0) lgkmcnt(0)
  s_barrier
L_fast1:
  s_cmp_lg_u32 s68, 0
  s_cbranch_scc1 L_slow
  v_mov_b32 v12, -2.0
  v_mov_b32 v13, -2.0
  v_lshrrev_b32 v16, 5, v14
  v_and_b32 v17, 31, v14
  v_lshlrev_b32 v7, 14, v16
  v_lshl_add_u32 v7, v17, 4, v7
  s_mul_i32 s69, s59, 4000
  s_add_u32 s69, s69, s60
  s_lshl_b32 s79, s69, 12
  s_lshl_b32 s69, s56, 10
  s_add_u32 s79, s79, s69
  v_lshrrev_b32 v16, 5, v14
  v_and_b32 v17, 31, v14
  v_mul_u32_u24 v4, 1040, v17
  v_lshl_add_u32 v4, v16, 5, v4
  v_add_u32 v4, 0x1de00, v4
  s_lshl_b32 s69, s56, 11
  s_add_u32 s69, s69, 155648
  v_lshlrev_b32 v5, 5, v16
  v_add_u32 v5, s69, v5
  v_lshlrev_b32 v6, 4, v14
  ds_read_b128 v[20:23], v4 offset:0
  ds_read_b128 v[24:27], v4 offset:16
  ds_read_b128 v[36:39], v5 offset:0
  ds_read_b128 v[40:43], v5 offset:16
  ds_read_b128 v[28:31], v4 offset:64
  ds_read_b128 v[32:35], v4 offset:80
  ds_read_b128 v[44:47], v5 offset:64
  ds_read_b128 v[48:51], v5 offset:80
  s_waitcnt lgkmcnt(4)
  ds_read_b128 a[0:3], v6 offset:0
  ds_read_b128 a[4:7], v6 offset:1024
  ds_read_b128 a[8:11], v6 offset:2048
  ds_read_b128 a[12:15], v6 offset:3072
  ds_read_b128 a[16:19], v6 offset:4096
  ds_read_b128 a[20:23], v6 offset:5120
  ds_read_b128 a[24:27], v6 offset:6144
  ds_read_b128 a[28:31], v6 offset:7168
  v_fma_f32 v20, v20, v36, 1.0
  v_fma_f32 v21, v21, v37, 1.0
  v_fma_f32 v22, v22, v38, 1.0
  v_fma_f32 v23, v23, v39, 1.0
  v_fma_f32 v24, v24, v40, 1.0
  v_fma_f32 v25, v25, v41, 1.0
  v_fma_f32 v26, v26, v42, 1.0
  v_fma_f32 v27, v27, v43, 1.0
  v_rcp_f32 v20, v20
  v_rcp_f32 v21, v21
  v_rcp_f32 v22, v22
  v_rcp_f32 v23, v23
  v_rcp_f32 v24, v24
  v_rcp_f32 v25, v25
  v_rcp_f32 v26, v26
  v_rcp_f32 v27, v27
  v_fma_f32 v20, v20, -2.0, 1.0
  v_fma_f32 v21, v21, -2.0, 1.0
  v_fma_f32 v22, v22, -2.0, 1.0
  v_fma_f32 v23, v23, -2.0, 1.0
  v_fma_f32 v24, v24, -2.0, 1.0
  v_fma_f32 v25, v25, -2.0, 1.0
  v_fma_f32 v26, v26, -2.0, 1.0
  v_fma_f32 v27, v27, -2.0, 1.0
  v_cvt_pk_bf16_f32 v52, v20, v21
  v_cvt_pk_bf16_f32 v53, v22, v23
  v_cvt_pk_bf16_f32 v54, v24, v25
  v_cvt_pk_bf16_f32 v55, v26, v27
  s_mov_b32 s61, 0
L_ok_f0:
  s_waitcnt lgkmcnt(6)
  s_nop 0
  v_mfma_f32_32x32x16_bf16 v[64:79], v[52:55], a[0:3], v[64:79]
  ds_read_b128 v[20:23], v4 offset:128
  ds_read_b128 v[24:27], v4 offset:144
  v_fma_f32 v28, v28, v44, 1.0
  v_fma_f32 v29, v29, v45, 1.0
  v_fma_f32 v30, v30, v46, 1.0
  v_fma_f32 v31, v31, v47, 1.0
  v_mfma_f32_32x32x16_bf16 v[80:95], v[52:55], a[4:7], v[80:95]
  ds_read_b128 v[36:39], v5 offset:128
  v_fma_f32 v32, v32, v48, 1.0
  v_fma_f32 v33, v33, v49, 1.0
  v_fma_f32 v34, v34, v50, 1.0
  v_fma_f32 v35, v35, v51, 1.0
  v_rcp_f32 v28, v28
  s_waitcnt lgkmcnt(7)
  v_mfma_f32_32x32x16_bf16 v[96:111], v[52:55], a[8:11], v[96:111]
  ds_read_b128 v[40:43], v5 offset:144
  ds_read_b128 a[32:35], v6 offset:8192
  v_rcp_f32 v29, v29
  v_rcp_f32 v30, v30
  v_mfma_f32_32x32x16_bf16 v[112:127], v[52:55], a[12:15], v[112:127]
  ds_read_b128 a[36:39], v6 offset:9216
  v_rcp_f32 v31, v31
  v_rcp_f32 v32, v32
  v_rcp_f32 v33, v33
  s_waitcnt lgkmcnt(8)
  v_mfma_f32_32x32x16_bf16 v[128:143], v[52:55], a[16:19], v[128:143]
  ds_read_b128 a[40:43], v6 offset:10240
  ds_read_b128 a[44:47], v6 offset:11264
  v_rcp_f32 v34, v34
  v_rcp_f32 v35, v35
  v_mfma_f32_32x32x16_bf16 v[144:159], v[52:55], a[20:23], v[144:159]
  ds_read_b128 a[48:51], v6 offset:12288
  v_fma_f32 v28, v28, -2.0, 1.0
  v_fma_f32 v29, v29, -2.0, 1.0
  v_fma_f32 v30, v30, -2.0, 1.0
  v_fma_f32 v31, v31, -2.0, 1.0
  v_fma_f32 v32, v32, -2.0, 1.0
  s_waitcnt lgkmcnt(9)
  v_mfma_f32_32x32x16_bf16 v[160:175], v[52:55], a[24:27], v[160:175]
  ds_read_b128 a[52:55], v6 offset:13312
  ds_read_b128 a[56:59], v6 offset:14336
  v_fma_f32 v33, v33, -2.0, 1.0
  v_fma_f32 v34, v34, -2.0, 1.0
  v_fma_f32 v35, v35, -2.0, 1.0
  v_cvt_pk_bf16_f32 v56, v28, v29
  v_mfma_f32_32x32x16_bf16 v[176:191], v[52:55], a[28:31], v[176:191]
  ds_read_b128 a[60:63], v6 offset:15360
  v_cvt_pk_bf16_f32 v57, v30, v31
  v_cvt_pk_bf16_f32 v58, v32, v33
  v_cvt_pk_bf16_f32 v59, v34, v35
  s_waitcnt lgkmcnt(6)
  s_nop 0
  v_mfma_f32_32x32x16_bf16 v[64:79], v[56:59], a[32:35], v[64:79]
  ds_read_b128 v[28:31], v4 offset:192
  ds_read_b128 v[32:35], v4 offset:208
  v_fma_f32 v20, v20, v36, 1.0
  v_fma_f32 v21, v21, v37, 1.0
  v_fma_f32 v22, v22, v38, 1.0
  v_fma_f32 v23, v23, v39, 1.0
  v_mfma_f32_32x32x16_bf16 v[80:95], v[56:59], a[36:39], v[80:95]
  ds_read_b128 v[44:47], v5 offset:192
  v_fma_f32 v24, v24, v40, 1.0
  v_fma_f32 v25, v25, v41, 1.0
  v_fma_f32 v26, v26, v42, 1.0
  v_fma_f32 v27, v27, v43, 1.0
  v_rcp_f32 v20, v20
  s_waitcnt lgkmcnt(7)
  v_mfma_f32_32x32x16_bf16 v[96:111], v[56:59], a[40:43], v[96:111]
  ds_read_b128 v[48:51], v5 offset:208
  ds_read_b128 a[0:3], v6 offset:16384
  v_rcp_f32 v21, v21
  v_rcp_f32 v22, v22
  v_mfma_f32_32x32x16_bf16 v[112:127], v[56:59], a[44:47], v[112:127]
  ds_read_b128 a[4:7], v6 offset:17408
  v_rcp_f32 v23, v23
  v_rcp_f32 v24, v24
  v_rcp_f32 v25, v25
  s_waitcnt lgkmcnt(8)
  v_mfma_f32_32x32x16_bf16 v[128:143], v[56:59], a[48:51], v[128:143]
  ds_read_b128 a[8:11], v6 offset:18432
  ds_read_b128 a[12:15], v6 offset:19456
  v_rcp_f32 v26, v26
  v_rcp_f32 v27, v27
  v_mfma_f32_32x32x16_bf16 v[144:159], v[56:59], a[52:55], v[144:159]
  ds_read_b128 a[16:19], v6 offset:20480
  v_fma_f32 v20, v20, -2.0, 1.0
  v_fma_f32 v21, v21, -2.0, 1.0
  v_fma_f32 v22, v22, -2.0, 1.0
  v_fma_f32 v23, v23, -2.0, 1.0
  v_fma_f32 v24, v24, -2.0, 1.0
  s_waitcnt lgkmcnt(9)
  v_mfma_f32_32x32x16_bf16 v[160:175], v[56:59], a[56:59], v[160:175]
  ds_read_b128 a[20:23], v6 offset:21504
  ds_read_b128 a[24:27], v6 offset:22528
  v_fma_f32 v25, v25, -2.0, 1.0
  v_fma_f32 v26, v26, -2.0, 1.0
  v_fma_f32 v27, v27, -2.0, 1.0
  v_cvt_pk_bf16_f32 v52, v20, v21
  v_mfma_f32_32x32x16_bf16 v[176:191], v[56:59], a[60:63], v[176:191]
  ds_read_b128 a[28:31], v6 offset:23552
  v_cvt_pk_bf16_f32 v53, v22, v23
  v_cvt_pk_bf16_f32 v54, v24, v25
  v_cvt_pk_bf16_f32 v55, v26, v27
  v_add_u32 v4, 0x80, v4
  v_add_u32 v5, 0x80, v5
  v_add_u32 v6, 0x4000, v6
  s_add_u32 s61, s61, 1
  s_cmp_lt_u32 s61, 7
  s_cbranch_scc1 L_ok_f0
  v_subrev_u32 v4, 0x380, v4
  v_add_u32 v5, 0x80, v5
  v_lshlrev_b32 v6, 4, v14
  s_waitcnt lgkmcnt(0)
  s_nop 0
  v_mfma_f32_32x32x16_bf16 v[64:79], v[52:55], a[192:195], v[64:79]
  ds_read_b128 v[20:23], v4 offset:0
  ds_read_b128 v[24:27], v4 offset:16
  v_fma_f32 v28, v28, v44, 1.0
  v_fma_f32 v29, v29, v45, 1.0
  v_fma_f32 v30, v30, v46, 1.0
  v_fma_f32 v31, v31, v47, 1.0
  v_mfma_f32_32x32x16_bf16 v[80:95], v[52:55], a[196:199], v[80:95]
  ds_read_b128 v[36:39], v5 offset:0
  v_fma_f32 v32, v32, v48, 1.0
  v_fma_f32 v33, v33, v49, 1.0
  v_fma_f32 v34, v34, v50, 1.0
  v_fma_f32 v35, v35, v51, 1.0
  v_rcp_f32 v28, v28
  v_mfma_f32_32x32x16_bf16 v[96:111], v[52:55], a[200:203], v[96:111]
  ds_read_b128 v[40:43], v5 offset:16
  v_rcp_f32 v29, v29
  v_rcp_f32 v30, v30
  v_rcp_f32 v31, v31
  v_mfma_f32_32x32x16_bf16 v[112:127], v[52:55], a[204:207], v[112:127]
  v_rcp_f32 v32, v32
  v_rcp_f32 v33, v33
  v_rcp_f32 v34, v34
  v_mfma_f32_32x32x16_bf16 v[128:143], v[52:55], a[208:211], v[128:143]
  v_rcp_f32 v35, v35
  v_fma_f32 v28, v28, -2.0, 1.0
  v_fma_f32 v29, v29, -2.0, 1.0
  v_fma_f32 v30, v30, -2.0, 1.0
  v_fma_f32 v31, v31, -2.0, 1.0
  v_mfma_f32_32x32x16_bf16 v[144:159], v[52:55], a[212:215], v[144:159]
  v_fma_f32 v32, v32, -2.0, 1.0
  v_fma_f32 v33, v33, -2.0, 1.0
  v_fma_f32 v34, v34, -2.0, 1.0
  v_fma_f32 v35, v35, -2.0, 1.0
  v_cvt_pk_bf16_f32 v56, v28, v29
  v_cvt_pk_bf16_f32 v57, v30, v31
  v_mfma_f32_32x32x16_bf16 v[160:175], v[52:55], a[216:219], v[160:175]
  v_cvt_pk_bf16_f32 v58, v32, v33
  v_cvt_pk_bf16_f32 v59, v34, v35
  v_mfma_f32_32x32x16_bf16 v[176:191], v[52:55], a[220:223], v[176:191]
  s_waitcnt lgkmcnt(0)
  s_nop 0
  v_mfma_f32_32x32x16_bf16 v[64:79], v[56:59], a[224:227], v[64:79]
  ds_read_b128 v[28:31], v4 offset:64
  ds_read_b128 v[32:35], v4 offset:80
  v_fma_f32 v20, v20, v36, 1.0
  v_fma_f32 v21, v21, v37, 1.0
  v_fma_f32 v22, v22, v38, 1.0
  v_fma_f32 v23, v23, v39, 1.0
  v_mfma_f32_32x32x16_bf16 v[80:95], v[56:59], a[228:231], v[80:95]
  ds_read_b128 v[44:47], v5 offset:64
  v_fma_f32 v24, v24, v40, 1.0
  v_fma_f32 v25, v25, v41, 1.0
  v_fma_f32 v26, v26, v42, 1.0
  v_fma_f32 v27, v27, v43, 1.0
  v_rcp_f32 v20, v20
  v_mfma_f32_32x32x16_bf16 v[96:111], v[56:59], a[232:235], v[96:111]
  ds_read_b128 v[48:51], v5 offset:80
  ds_read_b128 a[0:3], v6 offset:0
  v_rcp_f32 v21, v21
  v_rcp_f32 v22, v22
  v_mfma_f32_32x32x16_bf16 v[112:127], v[56:59], a[236:239], v[112:127]
  ds_read_b128 a[4:7], v6 offset:1024
  v_rcp_f32 v23, v23
  v_rcp_f32 v24, v24
  v_rcp_f32 v25, v25
  v_mfma_f32_32x32x16_bf16 v[128:143], v[56:59], a[240:243], v[128:143]
  ds_read_b128 a[8:11], v6 offset:2048
  ds_read_b128 a[12:15], v6 offset:3072
  v_rcp_f32 v26, v26
  v_rcp_f32 v27, v27
  v_mfma_f32_32x32x16_bf16 v[144:159], v[56:59], a[244:247], v[144:159]
  ds_read_b128 a[16:19], v6 offset:4096
  v_fma_f32 v20, v20, -2.0, 1.0
  v_fma_f32 v21, v21, -2.0, 1.0
  v_fma_f32 v22, v22, -2.0, 1.0
  v_fma_f32 v23, v23, -2.0, 1.0
  v_fma_f32 v24, v24, -2.0, 1.0
  v_mfma_f32_32x32x16_bf16 v[160:175], v[56:59], a[248:251], v[160:175]
  ds_read_b128 a[20:23], v6 offset:5120
  ds_read_b128 a[24:27], v6 offset:6144
  v_fma_f32 v25, v25, -2.0, 1.0
  v_fma_f32 v26, v26, -2.0, 1.0
  v_fma_f32 v27, v27, -2.0, 1.0
  v_cvt_pk_bf16_f32 v52, v20, v21
  v_mfma_f32_32x32x16_bf16 v[176:191], v[56:59], a[252:255], v[176:191]
  ds_read_b128 a[28:31], v6 offset:7168
  v_cvt_pk_bf16_f32 v53, v22, v23
  v_cvt_pk_bf16_f32 v54, v24, v25
  v_cvt_pk_bf16_f32 v55, v26, v27
  s_mov_b32 s61, 0
  s_mov_b32 s83, 0
  s_mov_b32 s82, s79
L_ok_f1:
  s_waitcnt lgkmcnt(6)
  s_nop 0
  v_mfma_f32_32x32x16_bf16 a[64:79], v[52:55], a[0:3], a[64:79]
  ds_read_b128 v[20:23], v4 offset:128
  ds_read_b128 v[24:27], v4 offset:144
  v_fma_f32 v28, v28, v44, 1.0
  v_fma_f32 v29, v29, v45, 1.0
  v_fma_f32 v30, v30, v46, 1.0
  v_fma_f32 v31, v31, v47, 1.0
  v_mfma_f32_32x32x16_bf16 a[80:95], v[52:55], a[4:7], a[80:95]
  ds_read_b128 v[36:39], v5 offset:128
  v_fma_f32 v32, v32, v48, 1.0
  v_fma_f32 v33, v33, v49, 1.0
  v_fma_f32 v34, v34, v50, 1.0
  v_fma_f32 v35, v35, v51, 1.0
  v_rcp_f32 v28, v28
  s_waitcnt lgkmcnt(7)
  v_mfma_f32_32x32x16_bf16 a[96:111], v[52:55], a[8:11], a[96:111]
  ds_read_b128 v[40:43], v5 offset:144
  ds_read_b128 a[32:35], v6 offset:8192
  v_rcp_f32 v29, v29
  v_rcp_f32 v30, v30
  v_mfma_f32_32x32x16_bf16 a[112:127], v[52:55], a[12:15], a[112:127]
  ds_read_b128 a[36:39], v6 offset:9216
  s_set_gpr_idx_on s83, 0x3
  s_nop 0
  v_cvt_pk_bf16_f32 v8, v64, v80
  v_cvt_pk_bf16_f32 v9, v96, v112
  v_cvt_pk_bf16_f32 v10, v128, v144
  v_cvt_pk_bf16_f32 v11, v160, v176
  s_set_gpr_idx_off
  s_add_u32 s83, s83, 1
  buffer_store_dwordx4 v[8:11], v7, s[28:31], s82 offen nt
  s_add_u32 s82, s82, 4096
  s_waitcnt lgkmcnt(8)
  v_mfma_f32_32x32x16_bf16 a[128:143], v[52:55], a[16:19], a[128:143]
  ds_read_b128 a[40:43], v6 offset:10240
  ds_read_b128 a[44:47], v6 offset:11264
  v_rcp_f32 v31, v31
  v_rcp_f32 v32, v32
  v_mfma_f32_32x32x16_bf16 a[144:159], v[52:55], a[20:23], a[144:159]
  ds_read_b128 a[48:51], v6 offset:12288
  v_rcp_f32 v33, v33
  v_rcp_f32 v34, v34
  v_rcp_f32 v35, v35
  s_waitcnt lgkmcnt(9)
  v_mfma_f32_32x32x16_bf16 a[160:175], v[52:55], a[24:27], a[160:175]
  ds_read_b128 a[52:55], v6 offset:13312
  ds_read_b128 a[56:59], v6 offset:14336
  v_fma_f32 v28, v28, -2.0, 1.0
  v_fma_f32 v29, v29, -2.0, 1.0
  v_fma_f32 v30, v30, -2.0, 1.0
  v_fma_f32 v31, v31, -2.0, 1.0
  v_mfma_f32_32x32x16_bf16 a[176:191], v[52:55], a[28:31], a[176:191]
  ds_read_b128 a[60:63], v6 offset:15360
  v_fma_f32 v32, v32, -2.0, 1.0
  v_fma_f32 v33, v33, -2.0, 1.0
  v_fma_f32 v34, v34, -2.0, 1.0
  v_fma_f32 v35, v35, -2.0, 1.0
  v_cvt_pk_bf16_f32 v56, v28, v29
  v_cvt_pk_bf16_f32 v57, v30, v31
  v_cvt_pk_bf16_f32 v58, v32, v33
  v_cvt_pk_bf16_f32 v59, v34, v35
  s_waitcnt lgkmcnt(6)
  s_nop 0
  v_mfma_f32_32x32x16_bf16 a[64:79], v[56:59], a[32:35], a[64:79]
  ds_read_b128 v[28:31], v4 offset:192
  ds_read_b128 v[32:35], v4 offset:208
  v_fma_f32 v20, v20, v36, 1.0
  v_fma_f32 v21, v21, v37, 1.0
  v_fma_f32 v22, v22, v38, 1.0
  v_fma_f32 v23, v23, v39, 1.0
  v_mfma_f32_32x32x16_bf16 a[80:95], v[56:59], a[36:39], a[80:95]
  ds_read_b128 v[44:47], v5 offset:192
  v_fma_f32 v24, v24, v40, 1.0
  v_fma_f32 v25, v25, v41, 1.0
  v_fma_f32 v26, v26, v42, 1.0
  v_fma_f32 v27, v27, v43, 1.0
  v_rcp_f32 v20, v20
  s_waitcnt lgkmcnt(7)
  v_mfma_f32_32x32x16_bf16 a[96:111], v[56:59], a[40:43], a[96:111]
  ds_read_b128 v[48:51], v5 offset:208
  ds_read_b128 a[0:3], v6 offset:16384
  v_rcp_f32 v21, v21
  v_rcp_f32 v22, v22
  v_mfma_f32_32x32x16_bf16 a[112:127], v[56:59], a[44:47], a[112:127]
  ds_read_b128 a[4:7], v6 offset:17408
  s_set_gpr_idx_on s83, 0x3
  s_nop 0
  v_cvt_pk_bf16_f32 v60, v64, v80
  v_cvt_pk_bf16_f32 v61, v96, v112
  v_cvt_pk_bf16_f32 v62, v128, v144
  v_cvt_pk_bf16_f32 v63, v160, v176
  s_set_gpr_idx_off
  s_add_u32 s83, s83, 1
  buffer_store_dwordx4 v[60:63], v7, s[28:31], s82 offen nt
  s_and_b32 s69, s61, 1
  s_lshl_b32 s69, s69, 14
  s_add_u32 s82, s82, s69
  s_add_u32 s82, s82, 4096
  s_waitcnt lgkmcnt(8)
  v_mfma_f32_32x32x16_bf16 a[128:143], v[56:59], a[48:51], a[128:143]
  ds_read_b128 a[8:11], v6 offset:18432
  ds_read_b128 a[12:15], v6 offset:19456
  v_rcp_f32 v23, v23
  v_rcp_f32 v24, v24
  v_mfma_f32_32x32x16_bf16 a[144:159], v[56:59], a[52:55], a[144:159]
  ds_read_b128 a[16:19], v6 offset:20480
  v_rcp_f32 v25, v25
  v_rcp_f32 v26, v26
  v_rcp_f32 v27, v27
  s_waitcnt lgkmcnt(9)
  v_mfma_f32_32x32x16_bf16 a[160:175], v[56:59], a[56:59], a[160:175]
  ds_read_b128 a[20:23], v6 offset:21504
  ds_read_b128 a[24:27], v6 offset:22528
  v_fma_f32 v20, v20, -2.0, 1.0
  v_fma_f32 v21, v21, -2.0, 1.0
  v_fma_f32 v22, v22, -2.0, 1.0
  v_fma_f32 v23, v23, -2.0, 1.0
  v_mfma_f32_32x32x16_bf16 a[176:191], v[56:59], a[60:63], a[176:191]
  ds_read_b128 a[28:31], v6 offset:23552
  v_fma_f32 v24, v24, -2.0, 1.0
  v_fma_f32 v25, v25, -2.0, 1.0
  v_fma_f32 v26, v26, -2.0, 1.0
  v_fma_f32 v27, v27, -2.0, 1.0
  v_cvt_pk_bf16_f32 v52, v20, v21
  v_cvt_pk_bf16_f32 v53, v22, v23
  v_cvt_pk_bf16_f32 v54, v24, v25
  v_cvt_pk_bf16_f32 v55, v26, v27
  v_add_u32 v4, 0x80, v4
  v_add_u32 v5, 0x80, v5
  v_add_u32 v6, 0x4000, v6
  s_add_u32 s61, s61, 1
  s_cmp_lt_u32 s61, 7
  s_cbranch_scc1 L_ok_f1
  s_waitcnt lgkmcnt(0)
  s_nop 0
  v_mfma_f32_32x32x16_bf16 a[64:79], v[52:55], a[192:195], a[64:79]
  v_fma_f32 v28, v28, v44, 1.0
  v_fma_f32 v29, v29, v45, 1.0
  v_fma_f32 v30, v30, v46, 1.0
  v_fma_f32 v31, v31, v47, 1.0
  v_fma_f32 v32, v32, v48, 1.0
  v_fma_f32 v33, v33, v49, 1.0
  v_mfma_f32_32x32x16_bf16 a[80:95], v[52:55], a[196:199], a[80:95]
  v_fma_f32 v34, v34, v50, 1.0
  v_fma_f32 v35, v35, v51, 1.0
  v_rcp_f32 v28, v28
  v_rcp_f32 v29, v29
  v_mfma_f32_32x32x16_bf16 a[96:111], v[52:55], a[200:203], a[96:111]
  v_rcp_f32 v30, v30
  v_rcp_f32 v31, v31
  v_rcp_f32 v32, v32
  v_mfma_f32_32x32x16_bf16 a[112:127], v[52:55], a[204:207], a[112:127]
  v_cvt_pk_bf16_f32 v8, v78, v94
  v_cvt_pk_bf16_f32 v9, v110, v126
  v_cvt_pk_bf16_f32 v10, v142, v158
  v_cvt_pk_bf16_f32 v11, v174, v190
  buffer_store_dwordx4 v[8:11], v7, s[28:31], s82 offen nt
  s_add_u32 s82, s82, 4096
  v_mfma_f32_32x32x16_bf16 a[128:143], v[52:55], a[208:211], a[128:143]
  v_rcp_f32 v33, v33
  v_rcp_f32 v34, v34
  v_rcp_f32 v35, v35
  v_mfma_f32_32x32x16_bf16 a[144:159], v[52:55], a[212:215], a[144:159]
  v_fma_f32 v28, v28, -2.0, 1.0
  v_fma_f32 v29, v29, -2.0, 1.0
  v_fma_f32 v30, v30, -2.0, 1.0
  v_fma_f32 v31, v31, -2.0, 1.0
  v_fma_f32 v32, v32, -2.0, 1.0
  v_fma_f32 v33, v33, -2.0, 1.0
  v_mfma_f32_32x32x16_bf16 a[160:175], v[52:55], a[216:219], a[160:175]
  v_fma_f32 v34, v34, -2.0, 1.0
  v_fma_f32 v35, v35, -2.0, 1.0
  v_cvt_pk_bf16_f32 v56, v28, v29
  v_cvt_pk_bf16_f32 v57, v30, v31
  v_cvt_pk_bf16_f32 v58, v32, v33
  v_cvt_pk_bf16_f32 v59, v34, v35
  v_mfma_f32_32x32x16_bf16 a[176:191], v[52:55], a[220:223], a[176:191]
  s_waitcnt lgkmcnt(0)
  s_nop 0
  v_mfma_f32_32x32x16_bf16 a[64:79], v[56:59], a[224:227], a[64:79]
  v_mfma_f32_32x32x16_bf16 a[80:95], v[56:59], a[228:231], a[80:95]
  v_mfma_f32_32x32x16_bf16 a[96:111], v[56:59], a[232:235], a[96:111]
  v_mfma_f32_32x32x16_bf16 a[112:127], v[56:59], a[236:239], a[112:127]
  v_cvt_pk_bf16_f32 v60, v79, v95
  v_cvt_pk_bf16_f32 v61, v111, v127
  v_cvt_pk_bf16_f32 v62, v143, v159
  v_cvt_pk_bf16_f32 v63, v175, v191
  buffer_store_dwordx4 v[60:63], v7, s[28:31], s82 offen nt
  v_mfma_f32_32x32x16_bf16 a[128:143], v[56:59], a[240:243], a[128:143]
  v_mfma_f32_32x32x16_bf16 a[144:159], v[56:59], a[244:247], a[144:159]
  v_mfma_f32_32x32x16_bf16 a[160:175], v[56:59], a[248:251], a[160:175]
  v_mfma_f32_32x32x16_bf16 a[176:191], v[56:59], a[252:255], a[176:191]
  s_nop 7
  s_nop 3
  s_add_u32 s69, s79, 512
  v_accvgpr_read_b32 v20, a64
  v_accvgpr_read_b32 v21, a80
  v_accvgpr_read_b32 v22, a96
  v_accvgpr_read_b32 v23, a112
  v_accvgpr_read_b32 v24, a128
  v_accvgpr_read_b32 v25, a144
  v_accvgpr_read_b32 v26, a160
  v_accvgpr_read_b32 v27, a176
  v_cvt_pk_bf16_f32 v28, v20, v21
  v_cvt_pk_bf16_f32 v29, v22, v23
  v_cvt_pk_bf16_f32 v30, v24, v25
  v_cvt_pk_bf16_f32 v31, v26, v27
  s_add_u32 s82, s69, 0
  buffer_store_dwordx4 v[28:31], v7, s[28:31], s82 offen nt
  v_accvgpr_read_b32 v36, a65
  v_accvgpr_read_b32 v37, a81
  v_accvgpr_read_b32 v38, a97
  v_accvgpr_read_b32 v39, a113
  v_accvgpr_read_b32 v40, a129
  v_accvgpr_read_b32 v41, a145
  v_accvgpr_read_b32 v42, a161
  v_accvgpr_read_b32 v43, a177
  v_cvt_pk_bf16_f32 v44, v36, v37
  v_cvt_pk_bf16_f32 v45, v38, v39
  v_cvt_pk_bf16_f32 v46, v40, v41
  v_cvt_pk_bf16_f32 v47, v42, v43
  s_add_u32 s82, s69, 4096
  buffer_store_dwordx4 v[44:47], v7, s[28:31], s82 offen nt
  v_accvgpr_read_b32 v20, a66
  v_accvgpr_read_b32 v21, a82
  v_accvgpr_read_b32 v22, a98
  v_accvgpr_read_b32 v23, a114
  v_accvgpr_read_b32 v24, a130
  v_accvgpr_read_b32 v25, a146
  v_accvgpr_read_b32 v26, a162
  v_accvgpr_read_b32 v27, a178
  v_cvt_pk_bf16_f32 v32, v20, v21
  v_cvt_pk_bf16_f32 v33, v22, v23
  v_cvt_pk_bf16_f32 v34, v24, v25
  v_cvt_pk_bf16_f32 v35, v26, v27
  s_add_u32 s82, s69, 8192
  buffer_store_dwordx4 v[32:35], v7, s[28:31], s82 offen nt
  v_accvgpr_read_b32 v36, a67
  v_accvgpr_read_b32 v37, a83
  v_accvgpr_read_b32 v38, a99
  v_accvgpr_read_b32 v39, a115
  v_accvgpr_read_b32 v40, a131
  v_accvgpr_read_b32 v41, a147
  v_accvgpr_read_b32 v42, a163
  v_accvgpr_read_b32 v43, a179
  v_cvt_pk_bf16_f32 v48, v36, v37
  v_cvt_pk_bf16_f32 v49, v38, v39
  v_cvt_pk_bf16_f32 v50, v40, v41
  v_cvt_pk_bf16_f32 v51, v42, v43
  s_add_u32 s82, s69, 12288
  buffer_store_dwordx4 v[48:51], v7, s[28:31], s82 offen nt
  v_accvgpr_read_b32 v20, a68
  v_accvgpr_read_b32 v21, a84
  v_accvgpr_read_b32 v22, a100
  v_accvgpr_read_b32 v23, a116
  v_accvgpr_read_b32 v24, a132
  v_accvgpr_read_b32 v25, a148
  v_accvgpr_read_b32 v26, a164
  v_accvgpr_read_b32 v27, a180
  v_cvt_pk_bf16_f32 v28, v20, v21
  v_cvt_pk_bf16_f32 v29, v22, v23
  v_cvt_pk_bf16_f32 v30, v24, v25
  v_cvt_pk_bf16_f32 v31, v26, v27
  s_add_u32 s82, s69, 32768
  buffer_store_dwordx4 v[28:31], v7, s[28:31], s82 offen nt
  v_accvgpr_read_b32 v36, a69
  v_accvgpr_read_b32 v37, a85
  v_accvgpr_read_b32 v38, a101
  v_accvgpr_read_b32 v39, a117
  v_accvgpr_read_b32 v40, a133
  v_accvgpr_read_b32 v41, a149
  v_accvgpr_read_b32 v42, a165
  v_accvgpr_read_b32 v43, a181
  v_cvt_pk_bf16_f32 v44, v36, v37
  v_cvt_pk_bf16_f32 v45, v38, v39
  v_cvt_pk_bf16_f32 v46, v40, v41
  v_cvt_pk_bf16_f32 v47, v42, v43
  s_add_u32 s82, s69, 36864
  buffer_store_dwordx4 v[44:47], v7, s[28:31], s82 offen nt
  v_accvgpr_read_b32 v20, a70
  v_accvgpr_read_b32 v21, a86
  v_accvgpr_read_b32 v22, a102
  v_accvgpr_read_b32 v23, a118
  v_accvgpr_read_b32 v24, a134
  v_accvgpr_read_b32 v25, a150
  v_accvgpr_read_b32 v26, a166
  v_accvgpr_read_b32 v27, a182
  v_cvt_pk_bf16_f32 v32, v20, v21
  v_cvt_pk_bf16_f32 v33, v22, v23
  v_cvt_pk_bf16_f32 v34, v24, v25
  v_cvt_pk_bf16_f32 v35, v26, v27
  s_add_u32 s82, s69, 40960
  buffer_store_dwordx4 v[32:35], v7, s[28:31], s82 offen nt
  v_accvgpr_read_b32 v36, a71
  v_accvgpr_read_b32 v37, a87
  v_accvgpr_read_b32 v38, a103
  v_accvgpr_read_b32 v39, a119
  v_accvgpr_read_b32 v40, a135
  v_accvgpr_read_b32 v41, a151
  v_accvgpr_read_b32 v42, a167
  v_accvgpr_read_b32 v43, a183
  v_cvt_pk_bf16_f32 v48, v36, v37
  v_cvt_pk_bf16_f32 v49, v38, v39
  v_cvt_pk_bf16_f32 v50, v40, v41
  v_cvt_pk_bf16_f32 v51, v42, v43
  s_add_u32 s82, s69, 45056
  buffer_store_dwordx4 v[48:51], v7, s[28:31], s82 offen nt
  v_accvgpr_read_b32 v20, a72
  v_accvgpr_read_b32 v21, a88
  v_accvgpr_read_b32 v22, a104
  v_accvgpr_read_b32 v23, a120
  v_accvgpr_read_b32 v24, a136
  v_accvgpr_read_b32 v25, a152
  v_accvgpr_read_b32 v26, a168
  v_accvgpr_read_b32 v27, a184
  v_cvt_pk_bf16_f32 v28, v20, v21
  v_cvt_pk_bf16_f32 v29, v22, v23
  v_cvt_pk_bf16_f32 v30, v24, v25
  v_cvt_pk_bf16_f32 v31, v26, v27
  s_add_u32 s82, s69, 65536
  buffer_store_dwordx4 v[28:31], v7, s[28:31], s82 offen nt
  v_accvgpr_read_b32 v36, a73
  v_accvgpr_read_b32 v37, a89
  v_accvgpr_read_b32 v38, a105
  v_accvgpr_read_b32 v39, a121
  v_accvgpr_read_b32 v40, a137
  v_accvgpr_read_b32 v41, a153
  v_accvgpr_read_b32 v42, a169
  v_accvgpr_read_b32 v43, a185
  v_cvt_pk_bf16_f32 v44, v36, v37
  v_cvt_pk_bf16_f32 v45, v38, v39
  v_cvt_pk_bf16_f32 v46, v40, v41
  v_cvt_pk_bf16_f32 v47, v42, v43
  s_add_u32 s82, s69, 69632
  buffer_store_dwordx4 v[44:47], v7, s[28:31], s82 offen nt
  v_accvgpr_read_b32 v20, a74
  v_accvgpr_read_b32 v21, a90
  v_accvgpr_read_b32 v22, a106
  v_accvgpr_read_b32 v23, a122
  v_accvgpr_read_b32 v24, a138
  v_accvgpr_read_b32 v25, a154
  v_accvgpr_read_b32 v26, a170
  v_accvgpr_read_b32 v27, a186
  v_cvt_pk_bf16_f32 v32, v20, v21
  v_cvt_pk_bf16_f32 v33, v22, v23
  v_cvt_pk_bf16_f32 v34, v24, v25
  v_cvt_pk_bf16_f32 v35, v26, v27
  s_add_u32 s82, s69, 73728
  buffer_store_dwordx4 v[32:35], v7, s[28:31], s82 offen nt
  v_accvgpr_read_b32 v36, a75
  v_accvgpr_read_b32 v37, a91
  v_accvgpr_read_b32 v38, a107
  v_accvgpr_read_b32 v39, a123
  v_accvgpr_read_b32 v40, a139
  v_accvgpr_read_b32 v41, a155
  v_accvgpr_read_b32 v42, a171
  v_accvgpr_read_b32 v43, a187
  v_cvt_pk_bf16_f32 v48, v36, v37
  v_cvt_pk_bf16_f32 v49, v38, v39
  v_cvt_pk_bf16_f32 v50, v40, v41
  v_cvt_pk_bf16_f32 v51, v42, v43
  s_add_u32 s82, s69, 77824
  buffer_store_dwordx4 v[48:51], v7, s[28:31], s82 offen nt
  v_accvgpr_read_b32 v20, a76
  v_accvgpr_read_b32 v21, a92
  v_accvgpr_read_b32 v22, a108
  v_accvgpr_read_b32 v23, a124
  v_accvgpr_read_b32 v24, a140
  v_accvgpr_read_b32 v25, a156
  v_accvgpr_read_b32 v26, a172
  v_accvgpr_read_b32 v27, a188
  v_cvt_pk_bf16_f32 v28, v20, v21
  v_cvt_pk_bf16_f32 v29, v22, v23
  v_cvt_pk_bf16_f32 v30, v24, v25
  v_cvt_pk_bf16_f32 v31, v26, v27
  s_add_u32 s82, s69, 98304
  buffer_store_dwordx4 v[28:31], v7, s[28:31], s82 offen nt
  v_accvgpr_read_b32 v36, a77
  v_accvgpr_read_b32 v37, a93
  v_accvgpr_read_b32 v38, a109
  v_accvgpr_read_b32 v39, a125
  v_accvgpr_read_b32 v40, a141
  v_accvgpr_read_b32 v41, a157
  v_accvgpr_read_b32 v42, a173
  v_accvgpr_read_b32 v43, a189
  v_cvt_pk_bf16_f32 v44, v36, v37
  v_cvt_pk_bf16_f32 v45, v38, v39
  v_cvt_pk_bf16_f32 v46, v40, v41
  v_cvt_pk_bf16_f32 v47, v42, v43
  s_add_u32 s82, s69, 102400
  buffer_store_dwordx4 v[44:47], v7, s[28:31], s82 offen nt
  v_accvgpr_read_b32 v20, a78
  v_accvgpr_read_b32 v21, a94
  v_accvgpr_read_b32 v22, a110
  v_accvgpr_read_b32 v23, a126
  v_accvgpr_read_b32 v24, a142
  v_accvgpr_read_b32 v25, a158
  v_accvgpr_read_b32 v26, a174
  v_accvgpr_read_b32 v27, a190
  v_cvt_pk_bf16_f32 v32, v20, v21
  v_cvt_pk_bf16_f32 v33, v22, v23
  v_cvt_pk_bf16_f32 v34, v24, v25
  v_cvt_pk_bf16_f32 v35, v26, v27
  s_add_u32 s82, s69, 106496
  buffer_store_dwordx4 v[32:35], v7, s[28:31], s82 offen nt
  v_accvgpr_read_b32 v36, a79
  v_accvgpr_read_b32 v37, a95
  v_accvgpr_read_b32 v38, a111
  v_accvgpr_read_b32 v39, a127
  v_accvgpr_read_b32 v40, a143
  v_accvgpr_read_b32 v41, a159
  v_accvgpr_read_b32 v42, a175
  v_accvgpr_read_b32 v43, a191
  v_cvt_pk_bf16_f32 v48, v36, v37
  v_cvt_pk_bf16_f32 v49, v38, v39
  v_cvt_pk_bf16_f32 v50, v40, v41
  v_cvt_pk_bf16_f32 v51, v42, v43
  s_add_u32 s82, s69, 110592
  buffer_store_dwordx4 v[48:51], v7, s[28:31], s82 offen nt
  s_endpgm
L_slow:
  v_mov_b32 v12, -2.0
  v_mov_b32 v13, -2.0
  v_lshrrev_b32 v16, 5, v14
  v_and_b32 v17, 31, v14
  v_lshlrev_b32 v7, 14, v16
  v_lshl_add_u32 v7, v17, 4, v7
  s_mul_i32 s69, s59, 4000
  s_add_u32 s69, s69, s60
  s_lshl_b32 s79, s69, 12
  s_lshl_b32 s69, s56, 10
  s_add_u32 s79, s79, s69
  v_lshrrev_b32 v16, 5, v14
  v_and_b32 v17, 31, v14
  v_mul_u32_u24 v4, 1040, v17
  v_lshl_add_u32 v4, v16, 5, v4
  v_add_u32 v4, 0x1de00, v4
  s_lshl_b32 s69, s56, 11
  s_add_u32 s69, s69, 155648
  v_lshlrev_b32 v5, 5, v16
  v_add_u32 v5, s69, v5
  v_lshlrev_b32 v6, 4, v14
  ds_read_b128 v[20:23], v4 offset:0
  ds_read_b128 v[24:27], v4 offset:16
  ds_read_b128 v[36:39], v5 offset:0
  ds_read_b128 v[40:43], v5 offset:16
  ds_read_b128 v[28:31], v4 offset:64
  ds_read_b128 v[32:35], v4 offset:80
  ds_read_b128 v[44:47], v5 offset:64
  ds_read_b128 v[48:51], v5 offset:80
  s_waitcnt lgkmcnt(4)
  ds_read_b128 a[0:3], v6 offset:0
  ds_read_b128 a[4:7], v6 offset:1024
  ds_read_b128 a[8:11], v6 offset:2048
  ds_read_b128 a[12:15], v6 offset:3072
  ds_read_b128 a[16:19], v6 offset:4096
  ds_read_b128 a[20:23], v6 offset:5120
  ds_read_b128 a[24:27], v6 offset:6144
  ds_read_b128 a[28:31], v6 offset:7168
  v_add_f32 v20, v20, v36
  v_add_f32 v21, v21, v37
  v_add_f32 v22, v22, v38
  v_add_f32 v23, v23, v39
  v_add_f32 v24, v24, v40
  v_add_f32 v25, v25, v41
  v_add_f32 v26, v26, v42
  v_add_f32 v27, v27, v43
  v_exp_f32 v20, v20
  v_exp_f32 v21, v21
  v_exp_f32 v22, v22
  v_exp_f32 v23, v23
  v_exp_f32 v24, v24
  v_exp_f32 v25, v25
  v_exp_f32 v26, v26
  v_exp_f32 v27, v27
  v_add_f32 v20, 1.0, v20
  v_add_f32 v21, 1.0, v21
  v_add_f32 v22, 1.0, v22
  v_add_f32 v23, 1.0, v23
  v_add_f32 v24, 1.0, v24
  v_add_f32 v25, 1.0, v25
  v_add_f32 v26, 1.0, v26
  v_add_f32 v27, 1.0, v27
  v_rcp_f32 v20, v20
  v_rcp_f32 v21, v21
  v_rcp_f32 v22, v22
  v_rcp_f32 v23, v23
  v_rcp_f32 v24, v24
  v_rcp_f32 v25, v25
  v_rcp_f32 v26, v26
  v_rcp_f32 v27, v27
  v_fma_f32 v20, v20, -2.0, 1.0
  v_fma_f32 v21, v21, -2.0, 1.0
  v_fma_f32 v22, v22, -2.0, 1.0
  v_fma_f32 v23, v23, -2.0, 1.0
  v_fma_f32 v24, v24, -2.0, 1.0
  v_fma_f32 v25, v25, -2.0, 1.0
  v_fma_f32 v26, v26, -2.0, 1.0
  v_fma_f32 v27, v27, -2.0, 1.0
  v_cvt_pk_bf16_f32 v52, v20, v21
  v_cvt_pk_bf16_f32 v53, v22, v23
  v_cvt_pk_bf16_f32 v54, v24, v25
  v_cvt_pk_bf16_f32 v55, v26, v27
  s_mov_b32 s61, 0
L_ok_s0:
  s_waitcnt lgkmcnt(6)
  s_nop 0
  v_mfma_f32_32x32x16_bf16 v[64:79], v[52:55], a[0:3], v[64:79]
  ds_read_b128 v[20:23], v4 offset:128
  ds_read_b128 v[24:27], v4 offset:144
  v_add_f32 v28, v28, v44
  v_add_f32 v29, v29, v45
  v_add_f32 v30, v30, v46
  v_add_f32 v31, v31, v47
  v_mfma_f32_32x32x16_bf16 v[80:95], v[52:55], a[4:7], v[80:95]
  ds_read_b128 v[36:39], v5 offset:128
  v_add_f32 v32, v32, v48
  v_add_f32 v33, v33, v49
  v_add_f32 v34, v34, v50
  v_add_f32 v35, v35, v51
  v_exp_f32 v28, v28
  s_waitcnt lgkmcnt(7)
  v_mfma_f32_32x32x16_bf16 v[96:111], v[52:55], a[8:11], v[96:111]
  ds_read_b128 v[40:43], v5 offset:144
  ds_read_b128 a[32:35], v6 offset:8192
  v_exp_f32 v29, v29
  v_exp_f32 v30, v30
  v_mfma_f32_32x32x16_bf16 v[112:127], v[52:55], a[12:15], v[112:127]
  ds_read_b128 a[36:39], v6 offset:9216
  v_exp_f32 v31, v31
  v_exp_f32 v32, v32
  v_exp_f32 v33, v33
  s_waitcnt lgkmcnt(8)
  v_mfma_f32_32x32x16_bf16 v[128:143], v[52:55], a[16:19], v[128:143]
  ds_read_b128 a[40:43], v6 offset:10240
  ds_read_b128 a[44:47], v6 offset:11264
  v_exp_f32 v34, v34
  v_exp_f32 v35, v35
  v_mfma_f32_32x32x16_bf16 v[144:159], v[52:55], a[20:23], v[144:159]
  ds_read_b128 a[48:51], v6 offset:12288
  v_add_f32 v28, 1.0, v28
  v_add_f32 v29, 1.0, v29
  v_add_f32 v30, 1.0, v30
  v_add_f32 v31, 1.0, v31
  v_add_f32 v32, 1.0, v32
  s_waitcnt lgkmcnt(9)
  v_mfma_f32_32x32x16_bf16 v[160:175], v[52:55], a[24:27], v[160:175]
  ds_read_b128 a[52:55], v6 offset:13312
  ds_read_b128 a[56:59], v6 offset:14336
  v_add_f32 v33, 1.0, v33
  v_add_f32 v34, 1.0, v34
  v_add_f32 v35, 1.0, v35
  v_rcp_f32 v28, v28
  v_mfma_f32_32x32x16_bf16 v[176:191], v[52:55], a[28:31], v[176:191]
  ds_read_b128 a[60:63], v6 offset:15360
  v_rcp_f32 v29, v29
  v_rcp_f32 v30, v30
  v_rcp_f32 v31, v31
  v_rcp_f32 v32, v32
  v_rcp_f32 v33, v33
  v_rcp_f32 v34, v34
  v_rcp_f32 v35, v35
  v_fma_f32 v28, v28, -2.0, 1.0
  v_fma_f32 v29, v29, -2.0, 1.0
  v_fma_f32 v30, v30, -2.0, 1.0
  v_fma_f32 v31, v31, -2.0, 1.0
  v_fma_f32 v32, v32, -2.0, 1.0
  v_fma_f32 v33, v33, -2.0, 1.0
  v_fma_f32 v34, v34, -2.0, 1.0
  v_fma_f32 v35, v35, -2.0, 1.0
  v_cvt_pk_bf16_f32 v56, v28, v29
  v_cvt_pk_bf16_f32 v57, v30, v31
  v_cvt_pk_bf16_f32 v58, v32, v33
  v_cvt_pk_bf16_f32 v59, v34, v35
  s_waitcnt lgkmcnt(6)
  s_nop 0
  v_mfma_f32_32x32x16_bf16 v[64:79], v[56:59], a[32:35], v[64:79]
  ds_read_b128 v[28:31], v4 offset:192
  ds_read_b128 v[32:35], v4 offset:208
  v_add_f32 v20, v20, v36
  v_add_f32 v21, v21, v37
  v_add_f32 v22, v22, v38
  v_add_f32 v23, v23, v39
  v_mfma_f32_32x32x16_bf16 v[80:95], v[56:59], a[36:39], v[80:95]
  ds_read_b128 v[44:47], v5 offset:192
  v_add_f32 v24, v24, v40
  v_add_f32 v25, v25, v41
  v_add_f32 v26, v26, v42
  v_add_f32 v27, v27, v43
  v_exp_f32 v20, v20
  s_waitcnt lgkmcnt(7)
  v_mfma_f32_32x32x16_bf16 v[96:111], v[56:59], a[40:43], v[96:111]
  ds_read_b128 v[48:51], v5 offset:208
  ds_read_b128 a[0:3], v6 offset:16384
  v_exp_f32 v21, v21
  v_exp_f32 v22, v22
  v_mfma_f32_32x32x16_bf16 v[112:127], v[56:59], a[44:47], v[112:127]
  ds_read_b128 a[4:7], v6 offset:17408
  v_exp_f32 v23, v23
  v_exp_f32 v24, v24
  v_exp_f32 v25, v25
  s_waitcnt lgkmcnt(8)
  v_mfma_f32_32x32x16_bf16 v[128:143], v[56:59], a[48:51], v[128:143]
  ds_read_b128 a[8:11], v6 offset:18432
  ds_read_b128 a[12:15], v6 offset:19456
  v_exp_f32 v26, v26
  v_exp_f32 v27, v27
  v_mfma_f32_32x32x16_bf16 v[144:159], v[56:59], a[52:55], v[144:159]
  ds_read_b128 a[16:19], v6 offset:20480
  v_add_f32 v20, 1.0, v20
  v_add_f32 v21, 1.0, v21
  v_add_f32 v22, 1.0, v22
  v_add_f32 v23, 1.0, v23
  v_add_f32 v24, 1.0, v24
  s_waitcnt lgkmcnt(9)
  v_mfma_f32_32x32x16_bf16 v[160:175], v[56:59], a[56:59], v[160:175]
  ds_read_b128 a[20:23], v6 offset:21504
  ds_read_b128 a[24:27], v6 offset:22528
  v_add_f32 v25, 1.0, v25
  v_add_f32 v26, 1.0, v26
  v_add_f32 v27, 1.0, v27
  v_rcp_f32 v20, v20
  v_mfma_f32_32x32x16_bf16 v[176:191], v[56:59], a[60:63], v[176:191]
  ds_read_b128 a[28:31], v6 offset:23552
  v_rcp_f32 v21, v21
  v_rcp_f32 v22, v22
  v_rcp_f32 v23, v23
  v_rcp_f32 v24, v24
  v_rcp_f32 v25, v25
  v_rcp_f32 v26, v26
  v_rcp_f32 v27, v27
  v_fma_f32 v20, v20, -2.0, 1.0
  v_fma_f32 v21, v21, -2.0, 1.0
  v_fma_f32 v22, v22, -2.0, 1.0
  v_fma_f32 v23, v23, -2.0, 1.0
  v_fma_f32 v24, v24, -2.0, 1.0
  v_fma_f32 v25, v25, -2.0, 1.0
  v_fma_f32 v26, v26, -2.0, 1.0
  v_fma_f32 v27, v27, -2.0, 1.0
  v_cvt_pk_bf16_f32 v52, v20, v21
  v_cvt_pk_bf16_f32 v53, v22, v23
  v_cvt_pk_bf16_f32 v54, v24, v25
  v_cvt_pk_bf16_f32 v55, v26, v27
  v_add_u32 v4, 0x80, v4
  v_add_u32 v5, 0x80, v5
  v_add_u32 v6, 0x4000, v6
  s_add_u32 s61, s61, 1
  s_cmp_lt_u32 s61, 7
  s_cbranch_scc1 L_ok_s0
  v_subrev_u32 v4, 0x380, v4
  v_add_u32 v5, 0x80, v5
  v_lshlrev_b32 v6, 4, v14
  s_waitcnt lgkmcnt(0)
  s_nop 0
  v_mfma_f32_32x32x16_bf16 v[64:79], v[52:55], a[192:195], v[64:79]
  ds_read_b128 v[20:23], v4 offset:0
  ds_read_b128 v[24:27], v4 offset:16
  v_add_f32 v28, v28, v44
  v_add_f32 v29, v29, v45
  v_add_f32 v30, v30, v46
  v_add_f32 v31, v31, v47
  v_mfma_f32_32x32x16_bf16 v[80:95], v[52:55], a[196:199], v[80:95]
  ds_read_b128 v[36:39], v5 offset:0
  v_add_f32 v32, v32, v48
  v_add_f32 v33, v33, v49
  v_add_f32 v34, v34, v50
  v_add_f32 v35, v35, v51
  v_exp_f32 v28, v28
  v_mfma_f32_32x32x16_bf16 v[96:111], v[52:55], a[200:203], v[96:111]
  ds_read_b128 v[40:43], v5 offset:16
  v_exp_f32 v29, v29
  v_exp_f32 v30, v30
  v_exp_f32 v31, v31
  v_mfma_f32_32x32x16_bf16 v[112:127], v[52:55], a[204:207], v[112:127]
  v_exp_f32 v32, v32
  v_exp_f32 v33, v33
  v_exp_f32 v34, v34
  v_mfma_f32_32x32x16_bf16 v[128:143], v[52:55], a[208:211], v[128:143]
  v_exp_f32 v35, v35
  v_add_f32 v28, 1.0, v28
  v_add_f32 v29, 1.0, v29
  v_add_f32 v30, 1.0, v30
  v_add_f32 v31, 1.0, v31
  v_mfma_f32_32x32x16_bf16 v[144:159], v[52:55], a[212:215], v[144:159]
  v_add_f32 v32, 1.0, v32
  v_add_f32 v33, 1.0, v33
  v_add_f32 v34, 1.0, v34
  v_add_f32 v35, 1.0, v35
  v_rcp_f32 v28, v28
  v_mfma_f32_32x32x16_bf16 v[160:175], v[52:55], a[216:219], v[160:175]
  v_rcp_f32 v29, v29
  v_rcp_f32 v30, v30
  v_rcp_f32 v31, v31
  v_mfma_f32_32x32x16_bf16 v[176:191], v[52:55], a[220:223], v[176:191]
  v_rcp_f32 v32, v32
  v_rcp_f32 v33, v33
  v_rcp_f32 v34, v34
  v_rcp_f32 v35, v35
  v_fma_f32 v28, v28, -2.0, 1.0
  v_fma_f32 v29, v29, -2.0, 1.0
  v_fma_f32 v30, v30, -2.0, 1.0
  v_fma_f32 v31, v31, -2.0, 1.0
  v_fma_f32 v32, v32, -2.0, 1.0
  v_fma_f32 v33, v33, -2.0, 1.0
  v_fma_f32 v34, v34, -2.0, 1.0
  v_fma_f32 v35, v35, -2.0, 1.0
  v_cvt_pk_bf16_f32 v56, v28, v29
  v_cvt_pk_bf16_f32 v57, v30, v31
  v_cvt_pk_bf16_f32 v58, v32, v33
  v_cvt_pk_bf16_f32 v59, v34, v35
  s_waitcnt lgkmcnt(0)
  s_nop 0
  v_mfma_f32_32x32x16_bf16 v[64:79], v[56:59], a[224:227], v[64:79]
  ds_read_b128 v[28:31], v4 offset:64
  ds_read_b128 v[32:35], v4 offset:80
  v_add_f32 v20, v20, v36
  v_add_f32 v21, v21, v37
  v_add_f32 v22, v22, v38
  v_add_f32 v23, v23, v39
  v_mfma_f32_32x32x16_bf16 v[80:95], v[56:59], a[228:231], v[80:95]
  ds_read_b128 v[44:47], v5 offset:64
  v_add_f32 v24, v24, v40
  v_add_f32 v25, v25, v41
  v_add_f32 v26, v26, v42
  v_add_f32 v27, v27, v43
  v_exp_f32 v20, v20
  v_mfma_f32_32x32x16_bf16 v[96:111], v[56:59], a[232:235], v[96:111]
  ds_read_b128 v[48:51], v5 offset:80
  ds_read_b128 a[0:3], v6 offset:0
  v_exp_f32 v21, v21
  v_exp_f32 v22, v22
  v_mfma_f32_32x32x16_bf16 v[112:127], v[56:59], a[236:239], v[112:127]
  ds_read_b128 a[4:7], v6 offset:1024
  v_exp_f32 v23, v23
  v_exp_f32 v24, v24
  v_exp_f32 v25, v25
  v_mfma_f32_32x32x16_bf16 v[128:143], v[56:59], a[240:243], v[128:143]
  ds_read_b128 a[8:11], v6 offset:2048
  ds_read_b128 a[12:15], v6 offset:3072
  v_exp_f32 v26, v26
  v_exp_f32 v27, v27
  v_mfma_f32_32x32x16_bf16 v[144:159], v[56:59], a[244:247], v[144:159]
  ds_read_b128 a[16:19], v6 offset:4096
  v_add_f32 v20, 1.0, v20
  v_add_f32 v21, 1.0, v21
  v_add_f32 v22, 1.0, v22
  v_add_f32 v23, 1.0, v23
  v_add_f32 v24, 1.0, v24
  v_mfma_f32_32x32x16_bf16 v[160:175], v[56:59], a[248:251], v[160:175]
  ds_read_b128 a[20:23], v6 offset:5120
  ds_read_b128 a[24:27], v6 offset:6144
  v_add_f32 v25, 1.0, v25
  v_add_f32 v26, 1.0, v26
  v_add_f32 v27, 1.0, v27
  v_rcp_f32 v20, v20
  v_mfma_f32_32x32x16_bf16 v[176:191], v[56:59], a[252:255], v[176:191]
  ds_read_b128 a[28:31], v6 offset:7168
  v_rcp_f32 v21, v21
  v_rcp_f32 v22, v22
  v_rcp_f32 v23, v23
  v_rcp_f32 v24, v24
  v_rcp_f32 v25, v25
  v_rcp_f32 v26, v26
  v_rcp_f32 v27, v27
  v_fma_f32 v20, v20, -2.0, 1.0
  v_fma_f32 v21, v21, -2.0, 1.0
  v_fma_f32 v22, v22, -2.0, 1.0
  v_fma_f32 v23, v23, -2.0, 1.0
  v_fma_f32 v24, v24, -2.0, 1.0
  v_fma_f32 v25, v25, -2.0, 1.0
  v_fma_f32 v26, v26, -2.0, 1.0
  v_fma_f32 v27, v27, -2.0, 1.0
  v_cvt_pk_bf16_f32 v52, v20, v21
  v_cvt_pk_bf16_f32 v53, v22, v23
  v_cvt_pk_bf16_f32 v54, v24, v25
  v_cvt_pk_bf16_f32 v55, v26, v27
  s_mov_b32 s61, 0
  s_mov_b32 s83, 0
  s_mov_b32 s82, s79
L_ok_s1:
  s_waitcnt lgkmcnt(6)
  s_nop 0
  v_mfma_f32_32x32x16_bf16 a[64:79], v[52:55], a[0:3], a[64:79]
  ds_read_b128 v[20:23], v4 offset:128
  ds_read_b128 v[24:27], v4 offset:144
  v_add_f32 v28, v28, v44
  v_add_f32 v29, v29, v45
  v_add_f32 v30, v30, v46
  v_add_f32 v31, v31, v47
  v_mfma_f32_32x32x16_bf16 a[80:95], v[52:55], a[4:7], a[80:95]
  ds_read_b128 v[36:39], v5 offset:128
  v_add_f32 v32, v32, v48
  v_add_f32 v33, v33, v49
  v_add_f32 v34, v34, v50
  v_add_f32 v35, v35, v51
  v_exp_f32 v28, v28
  s_waitcnt lgkmcnt(7)
  v_mfma_f32_32x32x16_bf16 a[96:111], v[52:55], a[8:11], a[96:111]
  ds_read_b128 v[40:43], v5 offset:144
  ds_read_b128 a[32:35], v6 offset:8192
  v_exp_f32 v29, v29
  v_exp_f32 v30, v30
  v_mfma_f32_32x32x16_bf16 a[112:127], v[52:55], a[12:15], a[112:127]
  ds_read_b128 a[36:39], v6 offset:9216
  s_set_gpr_idx_on s83, 0x3
  s_nop 0
  v_cvt_pk_bf16_f32 v8, v64, v80
  v_cvt_pk_bf16_f32 v9, v96, v112
  v_cvt_pk_bf16_f32 v10, v128, v144
  v_cvt_pk_bf16_f32 v11, v160, v176
  s_set_gpr_idx_off
  s_add_u32 s83, s83, 1
  buffer_store_dwordx4 v[8:11], v7, s[28:31], s82 offen nt
  s_add_u32 s82, s82, 4096
  s_waitcnt lgkmcnt(8)
  v_mfma_f32_32x32x16_bf16 a[128:143], v[52:55], a[16:19], a[128:143]
  ds_read_b128 a[40:43], v6 offset:10240
  ds_read_b128 a[44:47], v6 offset:11264
  v_exp_f32 v31, v31
  v_exp_f32 v32, v32
  v_mfma_f32_32x32x16_bf16 a[144:159], v[52:55], a[20:23], a[144:159]
  ds_read_b128 a[48:51], v6 offset:12288
  v_exp_f32 v33, v33
  v_exp_f32 v34, v34
  v_exp_f32 v35, v35
  s_waitcnt lgkmcnt(9)
  v_mfma_f32_32x32x16_bf16 a[160:175], v[52:55], a[24:27], a[160:175]
  ds_read_b128 a[52:55], v6 offset:13312
  ds_read_b128 a[56:59], v6 offset:14336
  v_add_f32 v28, 1.0, v28
  v_add_f32 v29, 1.0, v29
  v_add_f32 v30, 1.0, v30
  v_add_f32 v31, 1.0, v31
  v_mfma_f32_32x32x16_bf16 a[176:191], v[52:55], a[28:31], a[176:191]
  ds_read_b128 a[60:63], v6 offset:15360
  v_add_f32 v32, 1.0, v32
  v_add_f32 v33, 1.0, v33
  v_add_f32 v34, 1.0, v34
  v_add_f32 v35, 1.0, v35
  v_rcp_f32 v28, v28
  v_rcp_f32 v29, v29
  v_rcp_f32 v30, v30
  v_rcp_f32 v31, v31
  v_rcp_f32 v32, v32
  v_rcp_f32 v33, v33
  v_rcp_f32 v34, v34
  v_rcp_f32 v35, v35
  v_fma_f32 v28, v28, -2.0, 1.0
  v_fma_f32 v29, v29, -2.0, 1.0
  v_fma_f32 v30, v30, -2.0, 1.0
  v_fma_f32 v31, v31, -2.0, 1.0
  v_fma_f32 v32, v32, -2.0, 1.0
  v_fma_f32 v33, v33, -2.0, 1.0
  v_fma_f32 v34, v34, -2.0, 1.0
  v_fma_f32 v35, v35, -2.0, 1.0
  v_cvt_pk_bf16_f32 v56, v28, v29
  v_cvt_pk_bf16_f32 v57, v30, v31
  v_cvt_pk_bf16_f32 v58, v32, v33
  v_cvt_pk_bf16_f32 v59, v34, v35
  s_waitcnt lgkmcnt(6)
  s_nop 0
  v_mfma_f32_32x32x16_bf16 a[64:79], v[56:59], a[32:35], a[64:79]
  ds_read_b128 v[28:31], v4 offset:192
  ds_read_b128 v[32:35], v4 offset:208
  v_add_f32 v20, v20, v36
  v_add_f32 v21, v21, v37
  v_add_f32 v22, v22, v38
  v_add_f32 v23, v23, v39
  v_mfma_f32_32x32x16_bf16 a[80:95], v[56:59], a[36:39], a[80:95]
  ds_read_b128 v[44:47], v5 offset:192
  v_add_f32 v24, v24, v40
  v_add_f32 v25, v25, v41
  v_add_f32 v26, v26, v42
  v_add_f32 v27, v27, v43
  v_exp_f32 v20, v20
  s_waitcnt lgkmcnt(7)
  v_mfma_f32_32x32x16_bf16 a[96:111], v[56:59], a[40:43], a[96:111]
  ds_read_b128 v[48:51], v5 offset:208
  ds_read_b128 a[0:3], v6 offset:16384
  v_exp_f32 v21, v21
  v_exp_f32 v22, v22
  v_mfma_f32_32x32x16_bf16 a[112:127], v[56:59], a[44:47], a[112:127]
  ds_read_b128 a[4:7], v6 offset:17408
  s_set_gpr_idx_on s83, 0x3
  s_nop 0
  v_cvt_pk_bf16_f32 v60, v64, v80
  v_cvt_pk_bf16_f32 v61, v96, v112
  v_cvt_pk_bf16_f32 v62, v128, v144
  v_cvt_pk_bf16_f32 v63, v160, v176
  s_set_gpr_idx_off
  s_add_u32 s83, s83, 1
  buffer_store_dwordx4 v[60:63], v7, s[28:31], s82 offen nt
  s_and_b32 s69, s61, 1
  s_lshl_b32 s69, s69, 14
  s_add_u32 s82, s82, s69
  s_add_u32 s82, s82, 4096
  s_waitcnt lgkmcnt(8)
  v_mfma_f32_32x32x16_bf16 a[128:143], v[56:59], a[48:51], a[128:143]
  ds_read_b128 a[8:11], v6 offset:18432
  ds_read_b128 a[12:15], v6 offset:19456
  v_exp_f32 v23, v23
  v_exp_f32 v24, v24
  v_mfma_f32_32x32x16_bf16 a[144:159], v[56:59], a[52:55], a[144:159]
  ds_read_b128 a[16:19], v6 offset:20480
  v_exp_f32 v25, v25
  v_exp_f32 v26, v26
  v_exp_f32 v27, v27
  s_waitcnt lgkmcnt(9)
  v_mfma_f32_32x32x16_bf16 a[160:175], v[56:59], a[56:59], a[160:175]
  ds_read_b128 a[20:23], v6 offset:21504
  ds_read_b128 a[24:27], v6 offset:22528
  v_add_f32 v20, 1.0, v20
  v_add_f32 v21, 1.0, v21
  v_add_f32 v22, 1.0, v22
  v_add_f32 v23, 1.0, v23
  v_mfma_f32_32x32x16_bf16 a[176:191], v[56:59], a[60:63], a[176:191]
  ds_read_b128 a[28:31], v6 offset:23552
  v_add_f32 v24, 1.0, v24
  v_add_f32 v25, 1.0, v25
  v_add_f32 v26, 1.0, v26
  v_add_f32 v27, 1.0, v27
  v_rcp_f32 v20, v20
  v_rcp_f32 v21, v21
  v_rcp_f32 v22, v22
  v_rcp_f32 v23, v23
  v_rcp_f32 v24, v24
  v_rcp_f32 v25, v25
  v_rcp_f32 v26, v26
  v_rcp_f32 v27, v27
  v_fma_f32 v20, v20, -2.0, 1.0
  v_fma_f32 v21, v21, -2.0, 1.0
  v_fma_f32 v22, v22, -2.0, 1.0
  v_fma_f32 v23, v23, -2.0, 1.0
  v_fma_f32 v24, v24, -2.0, 1.0
  v_fma_f32 v25, v25, -2.0, 1.0
  v_fma_f32 v26, v26, -2.0, 1.0
  v_fma_f32 v27, v27, -2.0, 1.0
  v_cvt_pk_bf16_f32 v52, v20, v21
  v_cvt_pk_bf16_f32 v53, v22, v23
  v_cvt_pk_bf16_f32 v54, v24, v25
  v_cvt_pk_bf16_f32 v55, v26, v27
  v_add_u32 v4, 0x80, v4
  v_add_u32 v5, 0x80, v5
  v_add_u32 v6, 0x4000, v6
  s_add_u32 s61, s61, 1
  s_cmp_lt_u32 s61, 7
  s_cbranch_scc1 L_ok_s1
  s_waitcnt lgkmcnt(0)
  s_nop 0
  v_mfma_f32_32x32x16_bf16 a[64:79], v[52:55], a[192:195], a[64:79]
  v_add_f32 v28, v28, v44
  v_add_f32 v29, v29, v45
  v_add_f32 v30, v30, v46
  v_add_f32 v31, v31, v47
  v_add_f32 v32, v32, v48
  v_add_f32 v33, v33, v49
  v_mfma_f32_32x32x16_bf16 a[80:95], v[52:55], a[196:199], a[80:95]
  v_add_f32 v34, v34, v50
  v_add_f32 v35, v35, v51
  v_exp_f32 v28, v28
  v_exp_f32 v29, v29
  v_mfma_f32_32x32x16_bf16 a[96:111], v[52:55], a[200:203], a[96:111]
  v_exp_f32 v30, v30
  v_exp_f32 v31, v31
  v_exp_f32 v32, v32
  v_mfma_f32_32x32x16_bf16 a[112:127], v[52:55], a[204:207], a[112:127]
  v_cvt_pk_bf16_f32 v8, v78, v94
  v_cvt_pk_bf16_f32 v9, v110, v126
  v_cvt_pk_bf16_f32 v10, v142, v158
  v_cvt_pk_bf16_f32 v11, v174, v190
  buffer_store_dwordx4 v[8:11], v7, s[28:31], s82 offen nt
  s_add_u32 s82, s82, 4096
  v_mfma_f32_32x32x16_bf16 a[128:143], v[52:55], a[208:211], a[128:143]
  v_exp_f32 v33, v33
  v_exp_f32 v34, v34
  v_exp_f32 v35, v35
  v_mfma_f32_32x32x16_bf16 a[144:159], v[52:55], a[212:215], a[144:159]
  v_add_f32 v28, 1.0, v28
  v_add_f32 v29, 1.0, v29
  v_add_f32 v30, 1.0, v30
  v_add_f32 v31, 1.0, v31
  v_add_f32 v32, 1.0, v32
  v_add_f32 v33, 1.0, v33
  v_mfma_f32_32x32x16_bf16 a[160:175], v[52:55], a[216:219], a[160:175]
  v_add_f32 v34, 1.0, v34
  v_add_f32 v35, 1.0, v35
  v_rcp_f32 v28, v28
  v_rcp_f32 v29, v29
  v_mfma_f32_32x32x16_bf16 a[176:191], v[52:55], a[220:223], a[176:191]
  v_rcp_f32 v30, v30
  v_rcp_f32 v31, v31
  v_rcp_f32 v32, v32
  v_rcp_f32 v33, v33
  v_rcp_f32 v34, v34
  v_rcp_f32 v35, v35
  v_fma_f32 v28, v28, -2.0, 1.0
  v_fma_f32 v29, v29, -2.0, 1.0
  v_fma_f32 v30, v30, -2.0, 1.0
  v_fma_f32 v31, v31, -2.0, 1.0
  v_fma_f32 v32, v32, -2.0, 1.0
  v_fma_f32 v33, v33, -2.0, 1.0
  v_fma_f32 v34, v34, -2.0, 1.0
  v_fma_f32 v35, v35, -2.0, 1.0
  v_cvt_pk_bf16_f32 v56, v28, v29
  v_cvt_pk_bf16_f32 v57, v30, v31
  v_cvt_pk_bf16_f32 v58, v32, v33
  v_cvt_pk_bf16_f32 v59, v34, v35
  s_waitcnt lgkmcnt(0)
  s_nop 0
  v_mfma_f32_32x32x16_bf16 a[64:79], v[56:59], a[224:227], a[64:79]
  v_mfma_f32_32x32x16_bf16 a[80:95], v[56:59], a[228:231], a[80:95]
  v_mfma_f32_32x32x16_bf16 a[96:111], v[56:59], a[232:235], a[96:111]
  v_mfma_f32_32x32x16_bf16 a[112:127], v[56:59], a[236:239], a[112:127]
  v_cvt_pk_bf16_f32 v60, v79, v95
  v_cvt_pk_bf16_f32 v61, v111, v127
  v_cvt_pk_bf16_f32 v62, v143, v159
  v_cvt_pk_bf16_f32 v63, v175, v191
  buffer_store_dwordx4 v[60:63], v7, s[28:31], s82 offen nt
  v_mfma_f32_32x32x16_bf16 a[128:143], v[56:59], a[240:243], a[128:143]
  v_mfma_f32_32x32x16_bf16 a[144:159], v[56:59], a[244:247], a[144:159]
  v_mfma_f32_32x32x16_bf16 a[160:175], v[56:59], a[248:251], a[160:175]
  v_mfma_f32_32x32x16_bf16 a[176:191], v[56:59], a[252:255], a[176:191]
  s_nop 7
  s_nop 3
  s_add_u32 s69, s79, 512
  v_accvgpr_read_b32 v20, a64
  v_accvgpr_read_b32 v21, a80
  v_accvgpr_read_b32 v22, a96
  v_accvgpr_read_b32 v23, a112
  v_accvgpr_read_b32 v24, a128
  v_accvgpr_read_b32 v25, a144
  v_accvgpr_read_b32 v26, a160
  v_accvgpr_read_b32 v27, a176
  v_cvt_pk_bf16_f32 v28, v20, v21
  v_cvt_pk_bf16_f32 v29, v22, v23
  v_cvt_pk_bf16_f32 v30, v24, v25
  v_cvt_pk_bf16_f32 v31, v26, v27
  s_add_u32 s82, s69, 0
  buffer_store_dwordx4 v[28:31], v7, s[28:31], s82 offen nt
  v_accvgpr_read_b32 v36, a65
  v_accvgpr_read_b32 v37, a81
  v_accvgpr_read_b32 v38, a97
  v_accvgpr_read_b32 v39, a113
  v_accvgpr_read_b32 v40, a129
  v_accvgpr_read_b32 v41, a145
  v_accvgpr_read_b32 v42, a161
  v_accvgpr_read_b32 v43, a177
  v_cvt_pk_bf16_f32 v44, v36, v37
  v_cvt_pk_bf16_f32 v45, v38, v39
  v_cvt_pk_bf16_f32 v46, v40, v41
  v_cvt_pk_bf16_f32 v47, v42, v43
  s_add_u32 s82, s69, 4096
  buffer_store_dwordx4 v[44:47], v7, s[28:31], s82 offen nt
  v_accvgpr_read_b32 v20, a66
  v_accvgpr_read_b32 v21, a82
  v_accvgpr_read_b32 v22, a98
  v_accvgpr_read_b32 v23, a114
  v_accvgpr_read_b32 v24, a130
  v_accvgpr_read_b32 v25, a146
  v_accvgpr_read_b32 v26, a162
  v_accvgpr_read_b32 v27, a178
  v_cvt_pk_bf16_f32 v32, v20, v21
  v_cvt_pk_bf16_f32 v33, v22, v23
  v_cvt_pk_bf16_f32 v34, v24, v25
  v_cvt_pk_bf16_f32 v35, v26, v27
  s_add_u32 s82, s69, 8192
  buffer_store_dwordx4 v[32:35], v7, s[28:31], s82 offen nt
  v_accvgpr_read_b32 v36, a67
  v_accvgpr_read_b32 v37, a83
  v_accvgpr_read_b32 v38, a99
  v_accvgpr_read_b32 v39, a115
  v_accvgpr_read_b32 v40, a131
  v_accvgpr_read_b32 v41, a147
  v_accvgpr_read_b32 v42, a163
  v_accvgpr_read_b32 v43, a179
  v_cvt_pk_bf16_f32 v48, v36, v37
  v_cvt_pk_bf16_f32 v49, v38, v39
  v_cvt_pk_bf16_f32 v50, v40, v41
  v_cvt_pk_bf16_f32 v51, v42, v43
  s_add_u32 s82, s69, 12288
  buffer_store_dwordx4 v[48:51], v7, s[28:31], s82 offen nt
  v_accvgpr_read_b32 v20, a68
  v_accvgpr_read_b32 v21, a84
  v_accvgpr_read_b32 v22, a100
  v_accvgpr_read_b32 v23, a116
  v_accvgpr_read_b32 v24, a132
  v_accvgpr_read_b32 v25, a148
  v_accvgpr_read_b32 v26, a164
  v_accvgpr_read_b32 v27, a180
  v_cvt_pk_bf16_f32 v28, v20, v21
  v_cvt_pk_bf16_f32 v29, v22, v23
  v_cvt_pk_bf16_f32 v30, v24, v25
  v_cvt_pk_bf16_f32 v31, v26, v27
  s_add_u32 s82, s69, 32768
  buffer_store_dwordx4 v[28:31], v7, s[28:31], s82 offen nt
  v_accvgpr_read_b32 v36, a69
  v_accvgpr_read_b32 v37, a85
  v_accvgpr_read_b32 v38, a101
  v_accvgpr_read_b32 v39, a117
  v_accvgpr_read_b32 v40, a133
  v_accvgpr_read_b32 v41, a149
  v_accvgpr_read_b32 v42, a165
  v_accvgpr_read_b32 v43, a181
  v_cvt_pk_bf16_f32 v44, v36, v37
  v_cvt_pk_bf16_f32 v45, v38, v39
  v_cvt_pk_bf16_f32 v46, v40, v41
  v_cvt_pk_bf16_f32 v47, v42, v43
  s_add_u32 s82, s69, 36864
  buffer_store_dwordx4 v[44:47], v7, s[28:31], s82 offen nt
  v_accvgpr_read_b32 v20, a70
  v_accvgpr_read_b32 v21, a86
  v_accvgpr_read_b32 v22, a102
  v_accvgpr_read_b32 v23, a118
  v_accvgpr_read_b32 v24, a134
  v_accvgpr_read_b32 v25, a150
  v_accvgpr_read_b32 v26, a166
  v_accvgpr_read_b32 v27, a182
  v_cvt_pk_bf16_f32 v32, v20, v21
  v_cvt_pk_bf16_f32 v33, v22, v23
  v_cvt_pk_bf16_f32 v34, v24, v25
  v_cvt_pk_bf16_f32 v35, v26, v27
  s_add_u32 s82, s69, 40960
  buffer_store_dwordx4 v[32:35], v7, s[28:31], s82 offen nt
  v_accvgpr_read_b32 v36, a71
  v_accvgpr_read_b32 v37, a87
  v_accvgpr_read_b32 v38, a103
  v_accvgpr_read_b32 v39, a119
  v_accvgpr_read_b32 v40, a135
  v_accvgpr_read_b32 v41, a151
  v_accvgpr_read_b32 v42, a167
  v_accvgpr_read_b32 v43, a183
  v_cvt_pk_bf16_f32 v48, v36, v37
  v_cvt_pk_bf16_f32 v49, v38, v39
  v_cvt_pk_bf16_f32 v50, v40, v41
  v_cvt_pk_bf16_f32 v51, v42, v43
  s_add_u32 s82, s69, 45056
  buffer_store_dwordx4 v[48:51], v7, s[28:31], s82 offen nt
  v_accvgpr_read_b32 v20, a72
  v_accvgpr_read_b32 v21, a88
  v_accvgpr_read_b32 v22, a104
  v_accvgpr_read_b32 v23, a120
  v_accvgpr_read_b32 v24, a136
  v_accvgpr_read_b32 v25, a152
  v_accvgpr_read_b32 v26, a168
  v_accvgpr_read_b32 v27, a184
  v_cvt_pk_bf16_f32 v28, v20, v21
  v_cvt_pk_bf16_f32 v29, v22, v23
  v_cvt_pk_bf16_f32 v30, v24, v25
  v_cvt_pk_bf16_f32 v31, v26, v27
  s_add_u32 s82, s69, 65536
  buffer_store_dwordx4 v[28:31], v7, s[28:31], s82 offen nt
  v_accvgpr_read_b32 v36, a73
  v_accvgpr_read_b32 v37, a89
  v_accvgpr_read_b32 v38, a105
  v_accvgpr_read_b32 v39, a121
  v_accvgpr_read_b32 v40, a137
  v_accvgpr_read_b32 v41, a153
  v_accvgpr_read_b32 v42, a169
  v_accvgpr_read_b32 v43, a185
  v_cvt_pk_bf16_f32 v44, v36, v37
  v_cvt_pk_bf16_f32 v45, v38, v39
  v_cvt_pk_bf16_f32 v46, v40, v41
  v_cvt_pk_bf16_f32 v47, v42, v43
  s_add_u32 s82, s69, 69632
  buffer_store_dwordx4 v[44:47], v7, s[28:31], s82 offen nt
  v_accvgpr_read_b32 v20, a74
  v_accvgpr_read_b32 v21, a90
  v_accvgpr_read_b32 v22, a106
  v_accvgpr_read_b32 v23, a122
  v_accvgpr_read_b32 v24, a138
  v_accvgpr_read_b32 v25, a154
  v_accvgpr_read_b32 v26, a170
  v_accvgpr_read_b32 v27, a186
  v_cvt_pk_bf16_f32 v32, v20, v21
  v_cvt_pk_bf16_f32 v33, v22, v23
  v_cvt_pk_bf16_f32 v34, v24, v25
  v_cvt_pk_bf16_f32 v35, v26, v27
  s_add_u32 s82, s69, 73728
  buffer_store_dwordx4 v[32:35], v7, s[28:31], s82 offen nt
  v_accvgpr_read_b32 v36, a75
  v_accvgpr_read_b32 v37, a91
  v_accvgpr_read_b32 v38, a107
  v_accvgpr_read_b32 v39, a123
  v_accvgpr_read_b32 v40, a139
  v_accvgpr_read_b32 v41, a155
  v_accvgpr_read_b32 v42, a171
  v_accvgpr_read_b32 v43, a187
  v_cvt_pk_bf16_f32 v48, v36, v37
  v_cvt_pk_bf16_f32 v49, v38, v39
  v_cvt_pk_bf16_f32 v50, v40, v41
  v_cvt_pk_bf16_f32 v51, v42, v43
  s_add_u32 s82, s69, 77824
  buffer_store_dwordx4 v[48:51], v7, s[28:31], s82 offen nt
  v_accvgpr_read_b32 v20, a76
  v_accvgpr_read_b32 v21, a92
  v_accvgpr_read_b32 v22, a108
  v_accvgpr_read_b32 v23, a124
  v_accvgpr_read_b32 v24, a140
  v_accvgpr_read_b32 v25, a156
  v_accvgpr_read_b32 v26, a172
  v_accvgpr_read_b32 v27, a188
  v_cvt_pk_bf16_f32 v28, v20, v21
  v_cvt_pk_bf16_f32 v29, v22, v23
  v_cvt_pk_bf16_f32 v30, v24, v25
  v_cvt_pk_bf16_f32 v31, v26, v27
  s_add_u32 s82, s69, 98304
  buffer_store_dwordx4 v[28:31], v7, s[28:31], s82 offen nt
  v_accvgpr_read_b32 v36, a77
  v_accvgpr_read_b32 v37, a93
  v_accvgpr_read_b32 v38, a109
  v_accvgpr_read_b32 v39, a125
  v_accvgpr_read_b32 v40, a141
  v_accvgpr_read_b32 v41, a157
  v_accvgpr_read_b32 v42, a173
  v_accvgpr_read_b32 v43, a189
  v_cvt_pk_bf16_f32 v44, v36, v37
  v_cvt_pk_bf16_f32 v45, v38, v39
  v_cvt_pk_bf16_f32 v46, v40, v41
  v_cvt_pk_bf16_f32 v47, v42, v43
  s_add_u32 s82, s69, 102400
  buffer_store_dwordx4 v[44:47], v7, s[28:31], s82 offen nt
  v_accvgpr_read_b32 v20, a78
  v_accvgpr_read_b32 v21, a94
  v_accvgpr_read_b32 v22, a110
  v_accvgpr_read_b32 v23, a126
  v_accvgpr_read_b32 v24, a142
  v_accvgpr_read_b32 v25, a158
  v_accvgpr_read_b32 v26, a174
  v_accvgpr_read_b32 v27, a190
  v_cvt_pk_bf16_f32 v32, v20, v21
  v_cvt_pk_bf16_f32 v33, v22, v23
  v_cvt_pk_bf16_f32 v34, v24, v25
  v_cvt_pk_bf16_f32 v35, v26, v27
  s_add_u32 s82, s69, 106496
  buffer_store_dwordx4 v[32:35], v7, s[28:31], s82 offen nt
  v_accvgpr_read_b32 v36, a79
  v_accvgpr_read_b32 v37, a95
  v_accvgpr_read_b32 v38, a111
  v_accvgpr_read_b32 v39, a127
  v_accvgpr_read_b32 v40, a143
  v_accvgpr_read_b32 v41, a159
  v_accvgpr_read_b32 v42, a175
  v_accvgpr_read_b32 v43, a191
  v_cvt_pk_bf16_f32 v48, v36, v37
  v_cvt_pk_bf16_f32 v49, v38, v39
  v_cvt_pk_bf16_f32 v50, v40, v41
  v_cvt_pk_bf16_f32 v51, v42, v43
  s_add_u32 s82, s69, 110592
  buffer_store_dwordx4 v[48:51], v7, s[28:31], s82 offen nt
  s_endpgm
L_prod:
  s_lshl_b32 s92, s2, 2
  s_add_u32 s92, s92, s56
  s_lshr_b32 s93, s92, 1
  s_lshl_b32 s94, s93, 14
  s_lshl_b32 s95, s57, 8
  s_add_u32 s95, s94, s95
  v_lshlrev_b32 v30, 12, v21
  v_lshl_add_u32 v30, v22, 4, v30
  v_add_u32 v30, s95, v30
  s_lshl_b32 s95, s57, 13
  s_add_u32 s95, s94, s95
  v_lshlrev_b32 v32, 4, v14
  v_add_u32 v32, s95, v32
  s_waitcnt lgkmcnt(0)
  v_add_u32 v3, 0x0, v30
  global_load_dwordx4 v[64:67], v3, s[8:9] offset:0
  global_load_dwordx4 v[68:71], v3, s[8:9] offset:512
  global_load_dwordx4 v[72:75], v3, s[8:9] offset:1024
  global_load_dwordx4 v[76:79], v3, s[8:9] offset:1536
  global_load_dwordx4 v[80:83], v3, s[8:9] offset:2048
  global_load_dwordx4 v[84:87], v3, s[8:9] offset:2560
  global_load_dwordx4 v[88:91], v3, s[8:9] offset:3072
  global_load_dwordx4 v[92:95], v3, s[8:9] offset:3584
  v_add_u32 v3, 0x20000, v30
  global_load_dwordx4 v[96:99], v3, s[8:9] offset:0
  global_load_dwordx4 v[100:103], v3, s[8:9] offset:512
  global_load_dwordx4 v[104:107], v3, s[8:9] offset:1024
  global_load_dwordx4 v[108:111], v3, s[8:9] offset:1536
  global_load_dwordx4 v[112:115], v3, s[8:9] offset:2048
  global_load_dwordx4 v[116:119], v3, s[8:9] offset:2560
  global_load_dwordx4 v[120:123], v3, s[8:9] offset:3072
  global_load_dwordx4 v[124:127], v3, s[8:9] offset:3584
  v_add_u32 v3, 0x40000, v30
  global_load_dwordx4 v[128:131], v3, s[8:9] offset:0
  global_load_dwordx4 v[132:135], v3, s[8:9] offset:512
  global_load_dwordx4 v[136:139], v3, s[8:9] offset:1024
  global_load_dwordx4 v[140:143], v3, s[8:9] offset:1536
  global_load_dwordx4 v[144:147], v3, s[8:9] offset:2048
  global_load_dwordx4 v[148:151], v3, s[8:9] offset:2560
  global_load_dwordx4 v[152:155], v3, s[8:9] offset:3072
  global_load_dwordx4 v[156:159], v3, s[8:9] offset:3584
  s_waitcnt vmcnt(16)
  v_add_u32 v34, 0x10000, v32
  v_add_u32 v35, 0x1000, v34
  v_perm_b32 v36, v68, v64, s62
  v_perm_b32 v37, v76, v72, s62
  v_perm_b32 v38, v84, v80, s62
  v_perm_b32 v39, v92, v88, s62
  global_store_dwordx4 v34, v[36:39], s[80:81] offset:0 sc0 sc1
  v_perm_b32 v40, v68, v64, s63
  v_perm_b32 v41, v76, v72, s63
  v_perm_b32 v42, v84, v80, s63
  v_perm_b32 v43, v92, v88, s63
  global_store_dwordx4 v34, v[40:43], s[80:81] offset:1024 sc0 sc1
  v_perm_b32 v44, v69, v65, s62
  v_perm_b32 v45, v77, v73, s62
  v_perm_b32 v46, v85, v81, s62
  v_perm_b32 v47, v93, v89, s62
  global_store_dwordx4 v34, v[44:47], s[80:81] offset:2048 sc0 sc1
  v_perm_b32 v48, v69, v65, s63
  v_perm_b32 v49, v77, v73, s63
  v_perm_b32 v50, v85, v81, s63
  v_perm_b32 v51, v93, v89, s63
  global_store_dwordx4 v34, v[48:51], s[80:81] offset:3072 sc0 sc1
  v_perm_b32 v36, v70, v66, s62
  v_perm_b32 v37, v78, v74, s62
  v_perm_b32 v38, v86, v82, s62
  v_perm_b32 v39, v94, v90, s62
  global_store_dwordx4 v35, v[36:39], s[80:81] offset:0 sc0 sc1
  v_perm_b32 v40, v70, v66, s63
  v_perm_b32 v41, v78, v74, s63
  v_perm_b32 v42, v86, v82, s63
  v_perm_b32 v43, v94, v90, s63
  global_store_dwordx4 v35, v[40:43], s[80:81] offset:1024 sc0 sc1
  v_perm_b32 v44, v71, v67, s62
  v_perm_b32 v45, v79, v75, s62
  v_perm_b32 v46, v87, v83, s62
  v_perm_b32 v47, v95, v91, s62
  global_store_dwordx4 v35, v[44:47], s[80:81] offset:2048 sc0 sc1
  v_perm_b32 v48, v71, v67, s63
  v_perm_b32 v49, v79, v75, s63
  v_perm_b32 v50, v87, v83, s63
  v_perm_b32 v51, v95, v91, s63
  global_store_dwordx4 v35, v[48:51], s[80:81] offset:3072 sc0 sc1
  s_waitcnt vmcnt(16)
  v_add_u32 v34, 0x30000, v32
  v_add_u32 v35, 0x1000, v34
  v_perm_b32 v36, v100, v96, s62
  v_perm_b32 v37, v108, v104, s62
  v_perm_b32 v38, v116, v112, s62
  v_perm_b32 v39, v124, v120, s62
  global_store_dwordx4 v34, v[36:39], s[80:81] offset:0 sc0 sc1
  v_perm_b32 v40, v100, v96, s63
  v_perm_b32 v41, v108, v104, s63
  v_perm_b32 v42, v116, v112, s63
  v_perm_b32 v43, v124, v120, s63
  global_store_dwordx4 v34, v[40:43], s[80:81] offset:1024 sc0 sc1
  v_perm_b32 v44, v101, v97, s62
  v_perm_b32 v45, v109, v105, s62
  v_perm_b32 v46, v117, v113, s62
  v_perm_b32 v47, v125, v121, s62
  global_store_dwordx4 v34, v[44:47], s[80:81] offset:2048 sc0 sc1
  v_perm_b32 v48, v101, v97, s63
  v_perm_b32 v49, v109, v105, s63
  v_perm_b32 v50, v117, v113, s63
  v_perm_b32 v51, v125, v121, s63
  global_store_dwordx4 v34, v[48:51], s[80:81] offset:3072 sc0 sc1
  v_perm_b32 v36, v102, v98, s62
  v_perm_b32 v37, v110, v106, s62
  v_perm_b32 v38, v118, v114, s62
  v_perm_b32 v39, v126, v122, s62
  global_store_dwordx4 v35, v[36:39], s[80:81] offset:0 sc0 sc1
  v_perm_b32 v40, v102, v98, s63
  v_perm_b32 v41, v110, v106, s63
  v_perm_b32 v42, v118, v114, s63
  v_perm_b32 v43, v126, v122, s63
  global_store_dwordx4 v35, v[40:43], s[80:81] offset:1024 sc0 sc1
  v_perm_b32 v44, v103, v99, s62
  v_perm_b32 v45, v111, v107, s62
  v_perm_b32 v46, v119, v115, s62
  v_perm_b32 v47, v127, v123, s62
  global_store_dwordx4 v35, v[44:47], s[80:81] offset:2048 sc0 sc1
  v_perm_b32 v48, v103, v99, s63
  v_perm_b32 v49, v111, v107, s63
  v_perm_b32 v50, v119, v115, s63
  v_perm_b32 v51, v127, v123, s63
  global_store_dwordx4 v35, v[48:51], s[80:81] offset:3072 sc0 sc1
  s_waitcnt vmcnt(16)
  v_add_u32 v34, 0x50000, v32
  v_add_u32 v35, 0x1000, v34
  v_perm_b32 v36, v132, v128, s62
  v_perm_b32 v37, v140, v136, s62
  v_perm_b32 v38, v148, v144, s62
  v_perm_b32 v39, v156, v152, s62
  global_store_dwordx4 v34, v[36:39], s[80:81] offset:0 sc0 sc1
  v_perm_b32 v40, v132, v128, s63
  v_perm_b32 v41, v140, v136, s63
  v_perm_b32 v42, v148, v144, s63
  v_perm_b32 v43, v156, v152, s63
  global_store_dwordx4 v34, v[40:43], s[80:81] offset:1024 sc0 sc1
  v_perm_b32 v44, v133, v129, s62
  v_perm_b32 v45, v141, v137, s62
  v_perm_b32 v46, v149, v145, s62
  v_perm_b32 v47, v157, v153, s62
  global_store_dwordx4 v34, v[44:47], s[80:81] offset:2048 sc0 sc1
  v_perm_b32 v48, v133, v129, s63
  v_perm_b32 v49, v141, v137, s63
  v_perm_b32 v50, v149, v145, s63
  v_perm_b32 v51, v157, v153, s63
  global_store_dwordx4 v34, v[48:51], s[80:81] offset:3072 sc0 sc1
  v_perm_b32 v36, v134, v130, s62
  v_perm_b32 v37, v142, v138, s62
  v_perm_b32 v38, v150, v146, s62
  v_perm_b32 v39, v158, v154, s62
  global_store_dwordx4 v35, v[36:39], s[80:81] offset:0 sc0 sc1
  v_perm_b32 v40, v134, v130, s63
  v_perm_b32 v41, v142, v138, s63
  v_perm_b32 v42, v150, v146, s63
  v_perm_b32 v43, v158, v154, s63
  global_store_dwordx4 v35, v[40:43], s[80:81] offset:1024 sc0 sc1
  v_perm_b32 v44, v135, v131, s62
  v_perm_b32 v45, v143, v139, s62
  v_perm_b32 v46, v151, v147, s62
  v_perm_b32 v47, v159, v155, s62
  global_store_dwordx4 v35, v[44:47], s[80:81] offset:2048 sc0 sc1
  v_perm_b32 v48, v135, v131, s63
  v_perm_b32 v49, v143, v139, s63
  v_perm_b32 v50, v151, v147, s63
  v_perm_b32 v51, v159, v155, s63
  global_store_dwordx4 v35, v[48:51], s[80:81] offset:3072 sc0 sc1
  s_lshl_b32 s94, s92, 2
  s_add_u32 s94, s94, 64
  v_mov_b32 v34, s94
  v_mov_b32 v35, 1
  s_waitcnt vmcnt(0)
  s_mov_b32 exec_lo, 1
  s_mov_b32 exec_hi, 0
  global_store_dword v34, v35, s[84:85] sc0 sc1
  s_mov_b64 exec, -1
  s_cmp_lt_u32 s2, 2
  s_cbranch_scc1 L_prodg
  s_sub_u32 s92, s2, 2
  s_lshl_b32 s92, s92, 2
  s_add_u32 s92, s92, s56
  s_lshl_b32 s94, s92, 14
  v_lshlrev_b32 v30, 12, v21
  v_lshl_add_u32 v30, v22, 4, v30
  v_add_u32 v30, s94, v30
  v_lshlrev_b32 v31, 12, v23
  v_lshl_add_u32 v31, v24, 4, v31
  v_add_u32 v31, s94, v31
  v_lshlrev_b32 v32, 4, v14
  v_add_u32 v32, s94, v32
  s_waitcnt lgkmcnt(0)
  v_add_u32 v3, 0x0, v30
  global_load_dwordx4 v[64:67], v3, s[12:13] offset:0
  global_load_dwordx4 v[68:71], v3, s[12:13] offset:512
  global_load_dwordx4 v[72:75], v3, s[12:13] offset:1024
  global_load_dwordx4 v[76:79], v3, s[12:13] offset:1536
  global_load_dwordx4 v[80:83], v3, s[12:13] offset:2048
  global_load_dwordx4 v[84:87], v3, s[12:13] offset:2560
  global_load_dwordx4 v[88:91], v3, s[12:13] offset:3072
  global_load_dwordx4 v[92:95], v3, s[12:13] offset:3584
  v_add_u32 v3, 0x100, v30
  global_load_dwordx4 v[96:99], v3, s[12:13] offset:0
  global_load_dwordx4 v[100:103], v3, s[12:13] offset:512
  global_load_dwordx4 v[104:107], v3, s[12:13] offset:1024
  global_load_dwordx4 v[108:111], v3, s[12:13] offset:1536
  global_load_dwordx4 v[112:115], v3, s[12:13] offset:2048
  global_load_dwordx4 v[116:119], v3, s[12:13] offset:2560
  global_load_dwordx4 v[120:123], v3, s[12:13] offset:3072
  global_load_dwordx4 v[124:127], v3, s[12:13] offset:3584
  v_add_u32 v3, 0x0, v31
  global_load_dwordx4 v[128:131], v3, s[16:17] offset:0
  global_load_dwordx4 v[132:135], v3, s[16:17] offset:512
  global_load_dwordx4 v[136:139], v3, s[16:17] offset:1024
  global_load_dwordx4 v[140:143], v3, s[16:17] offset:1536
  global_load_dwordx4 v[144:147], v3, s[16:17] offset:2048
  global_load_dwordx4 v[148:151], v3, s[16:17] offset:2560
  global_load_dwordx4 v[152:155], v3, s[16:17] offset:3072
  global_load_dwordx4 v[156:159], v3, s[16:17] offset:3584
  v_add_u32 v3, 0x2000, v31
  global_load_dwordx4 v[160:163], v3, s[16:17] offset:0
  global_load_dwordx4 v[164:167], v3, s[16:17] offset:512
  global_load_dwordx4 v[168:171], v3, s[16:17] offset:1024
  global_load_dwordx4 v[172:175], v3, s[16:17] offset:1536
  global_load_dwordx4 v[176:179], v3, s[16:17] offset:2048
  global_load_dwordx4 v[180:183], v3, s[16:17] offset:2560
  global_load_dwordx4 v[184:187], v3, s[16:17] offset:3072
  global_load_dwordx4 v[188:191], v3, s[16:17] offset:3584
  s_waitcnt vmcnt(24)
  v_add_u32 v34, 0x70000, v32
  v_add_u32 v35, 0x1000, v34
  v_perm_b32 v36, v68, v64, s62
  v_perm_b32 v37, v76, v72, s62
  v_perm_b32 v38, v84, v80, s62
  v_perm_b32 v39, v92, v88, s62
  global_store_dwordx4 v34, v[36:39], s[80:81] offset:0 sc0 sc1
  v_perm_b32 v40, v68, v64, s63
  v_perm_b32 v41, v76, v72, s63
  v_perm_b32 v42, v84, v80, s63
  v_perm_b32 v43, v92, v88, s63
  global_store_dwordx4 v34, v[40:43], s[80:81] offset:1024 sc0 sc1
  v_perm_b32 v44, v69, v65, s62
  v_perm_b32 v45, v77, v73, s62
  v_perm_b32 v46, v85, v81, s62
  v_perm_b32 v47, v93, v89, s62
  global_store_dwordx4 v34, v[44:47], s[80:81] offset:2048 sc0 sc1
  v_perm_b32 v48, v69, v65, s63
  v_perm_b32 v49, v77, v73, s63
  v_perm_b32 v50, v85, v81, s63
  v_perm_b32 v51, v93, v89, s63
  global_store_dwordx4 v34, v[48:51], s[80:81] offset:3072 sc0 sc1
  v_perm_b32 v36, v70, v66, s62
  v_perm_b32 v37, v78, v74, s62
  v_perm_b32 v38, v86, v82, s62
  v_perm_b32 v39, v94, v90, s62
  global_store_dwordx4 v35, v[36:39], s[80:81] offset:0 sc0 sc1
  v_perm_b32 v40, v70, v66, s63
  v_perm_b32 v41, v78, v74, s63
  v_perm_b32 v42, v86, v82, s63
  v_perm_b32 v43, v94, v90, s63
  global_store_dwordx4 v35, v[40:43], s[80:81] offset:1024 sc0 sc1
  v_perm_b32 v44, v71, v67, s62
  v_perm_b32 v45, v79, v75, s62
  v_perm_b32 v46, v87, v83, s62
  v_perm_b32 v47, v95, v91, s62
  global_store_dwordx4 v35, v[44:47], s[80:81] offset:2048 sc0 sc1
  v_perm_b32 v48, v71, v67, s63
  v_perm_b32 v49, v79, v75, s63
  v_perm_b32 v50, v87, v83, s63
  v_perm_b32 v51, v95, v91, s63
  global_store_dwordx4 v35, v[48:51], s[80:81] offset:3072 sc0 sc1
  s_waitcnt vmcnt(24)
  v_add_u32 v34, 0x72000, v32
  v_add_u32 v35, 0x1000, v34
  v_perm_b32 v36, v100, v96, s62
  v_perm_b32 v37, v108, v104, s62
  v_perm_b32 v38, v116, v112, s62
  v_perm_b32 v39, v124, v120, s62
  global_store_dwordx4 v34, v[36:39], s[80:81] offset:0 sc0 sc1
  v_perm_b32 v40, v100, v96, s63
  v_perm_b32 v41, v108, v104, s63
  v_perm_b32 v42, v116, v112, s63
  v_perm_b32 v43, v124, v120, s63
  global_store_dwordx4 v34, v[40:43], s[80:81] offset:1024 sc0 sc1
  v_perm_b32 v44, v101, v97, s62
  v_perm_b32 v45, v109, v105, s62
  v_perm_b32 v46, v117, v113, s62
  v_perm_b32 v47, v125, v121, s62
  global_store_dwordx4 v34, v[44:47], s[80:81] offset:2048 sc0 sc1
  v_perm_b32 v48, v101, v97, s63
  v_perm_b32 v49, v109, v105, s63
  v_perm_b32 v50, v117, v113, s63
  v_perm_b32 v51, v125, v121, s63
  global_store_dwordx4 v34, v[48:51], s[80:81] offset:3072 sc0 sc1
  v_perm_b32 v36, v102, v98, s62
  v_perm_b32 v37, v110, v106, s62
  v_perm_b32 v38, v118, v114, s62
  v_perm_b32 v39, v126, v122, s62
  global_store_dwordx4 v35, v[36:39], s[80:81] offset:0 sc0 sc1
  v_perm_b32 v40, v102, v98, s63
  v_perm_b32 v41, v110, v106, s63
  v_perm_b32 v42, v118, v114, s63
  v_perm_b32 v43, v126, v122, s63
  global_store_dwordx4 v35, v[40:43], s[80:81] offset:1024 sc0 sc1
  v_perm_b32 v44, v103, v99, s62
  v_perm_b32 v45, v111, v107, s62
  v_perm_b32 v46, v119, v115, s62
  v_perm_b32 v47, v127, v123, s62
  global_store_dwordx4 v35, v[44:47], s[80:81] offset:2048 sc0 sc1
  v_perm_b32 v48, v103, v99, s63
  v_perm_b32 v49, v111, v107, s63
  v_perm_b32 v50, v119, v115, s63
  v_perm_b32 v51, v127, v123, s63
  global_store_dwordx4 v35, v[48:51], s[80:81] offset:3072 sc0 sc1
  s_waitcnt vmcnt(24)
  v_add_u32 v34, 0x90000, v32
  v_add_u32 v35, 0x1000, v34
  v_perm_b32 v36, v132, v128, s62
  v_perm_b32 v37, v140, v136, s62
  v_perm_b32 v38, v148, v144, s62
  v_perm_b32 v39, v156, v152, s62
  global_store_dwordx4 v34, v[36:39], s[80:81] offset:0 sc0 sc1
  v_perm_b32 v40, v132, v128, s63
  v_perm_b32 v41, v140, v136, s63
  v_perm_b32 v42, v148, v144, s63
  v_perm_b32 v43, v156, v152, s63
  global_store_dwordx4 v34, v[40:43], s[80:81] offset:1024 sc0 sc1
  v_perm_b32 v44, v133, v129, s62
  v_perm_b32 v45, v141, v137, s62
  v_perm_b32 v46, v149, v145, s62
  v_perm_b32 v47, v157, v153, s62
  global_store_dwordx4 v34, v[44:47], s[80:81] offset:2048 sc0 sc1
  v_perm_b32 v48, v133, v129, s63
  v_perm_b32 v49, v141, v137, s63
  v_perm_b32 v50, v149, v145, s63
  v_perm_b32 v51, v157, v153, s63
  global_store_dwordx4 v34, v[48:51], s[80:81] offset:3072 sc0 sc1
  v_perm_b32 v36, v134, v130, s62
  v_perm_b32 v37, v142, v138, s62
  v_perm_b32 v38, v150, v146, s62
  v_perm_b32 v39, v158, v154, s62
  global_store_dwordx4 v35, v[36:39], s[80:81] offset:0 sc0 sc1
  v_perm_b32 v40, v134, v130, s63
  v_perm_b32 v41, v142, v138, s63
  v_perm_b32 v42, v150, v146, s63
  v_perm_b32 v43, v158, v154, s63
  global_store_dwordx4 v35, v[40:43], s[80:81] offset:1024 sc0 sc1
  v_perm_b32 v44, v135, v131, s62
  v_perm_b32 v45, v143, v139, s62
  v_perm_b32 v46, v151, v147, s62
  v_perm_b32 v47, v159, v155, s62
  global_store_dwordx4 v35, v[44:47], s[80:81] offset:2048 sc0 sc1
  v_perm_b32 v48, v135, v131, s63
  v_perm_b32 v49, v143, v139, s63
  v_perm_b32 v50, v151, v147, s63
  v_perm_b32 v51, v159, v155, s63
  global_store_dwordx4 v35, v[48:51], s[80:81] offset:3072 sc0 sc1
  s_waitcnt vmcnt(24)
  v_add_u32 v34, 0x92000, v32
  v_add_u32 v35, 0x1000, v34
  v_perm_b32 v36, v164, v160, s62
  v_perm_b32 v37, v172, v168, s62
  v_perm_b32 v38, v180, v176, s62
  v_perm_b32 v39, v188, v184, s62
  global_store_dwordx4 v34, v[36:39], s[80:81] offset:0 sc0 sc1
  v_perm_b32 v40, v164, v160, s63
  v_perm_b32 v41, v172, v168, s63
  v_perm_b32 v42, v180, v176, s63
  v_perm_b32 v43, v188, v184, s63
  global_store_dwordx4 v34, v[40:43], s[80:81] offset:1024 sc0 sc1
  v_perm_b32 v44, v165, v161, s62
  v_perm_b32 v45, v173, v169, s62
  v_perm_b32 v46, v181, v177, s62
  v_perm_b32 v47, v189, v185, s62
  global_store_dwordx4 v34, v[44:47], s[80:81] offset:2048 sc0 sc1
  v_perm_b32 v48, v165, v161, s63
  v_perm_b32 v49, v173, v169, s63
  v_perm_b32 v50, v181, v177, s63
  v_perm_b32 v51, v189, v185, s63
  global_store_dwordx4 v34, v[48:51], s[80:81] offset:3072 sc0 sc1
  v_perm_b32 v36, v166, v162, s62
  v_perm_b32 v37, v174, v170, s62
  v_perm_b32 v38, v182, v178, s62
  v_perm_b32 v39, v190, v186, s62
  global_store_dwordx4 v35, v[36:39], s[80:81] offset:0 sc0 sc1
  v_perm_b32 v40, v166, v162, s63
  v_perm_b32 v41, v174, v170, s63
  v_perm_b32 v42, v182, v178, s63
  v_perm_b32 v43, v190, v186, s63
  global_store_dwordx4 v35, v[40:43], s[80:81] offset:1024 sc0 sc1
  v_perm_b32 v44, v167, v163, s62
  v_perm_b32 v45, v175, v171, s62
  v_perm_b32 v46, v183, v179, s62
  v_perm_b32 v47, v191, v187, s62
  global_store_dwordx4 v35, v[44:47], s[80:81] offset:2048 sc0 sc1
  v_perm_b32 v48, v167, v163, s63
  v_perm_b32 v49, v175, v171, s63
  v_perm_b32 v50, v183, v179, s63
  v_perm_b32 v51, v191, v187, s63
  global_store_dwordx4 v35, v[48:51], s[80:81] offset:3072 sc0 sc1
  s_lshl_b32 s94, s92, 2
  s_add_u32 s94, s94, 32
  v_mov_b32 v34, s94
  v_mov_b32 v35, 1
  s_waitcnt vmcnt(0)
  s_mov_b32 exec_lo, 1
  s_mov_b32 exec_hi, 0
  global_store_dword v34, v35, s[84:85] sc0 sc1
  s_endpgm
L_prodg:
  s_lshl_b32 s69, s2, 12
  s_lshl_b32 s70, s58, 6
  s_add_u32 s69, s69, s70
  v_lshlrev_b32 v25, 9, v22
  v_lshl_add_u32 v25, v21, 4, v25
  v_add_u32 v25, s69, v25
  s_waitcnt lgkmcnt(0)
  s_mov_b32 s24, s10
  s_and_b32 s25, s11, 0xffff
  s_mov_b32 s26, 8192
  s_mov_b32 s27, 0x00020000
  buffer_load_dwordx4 a[232:235], v25, s[24:27], 0 offen offset:0
  buffer_load_dwordx4 a[236:239], v25, s[24:27], 0 offen offset:128
  buffer_load_dwordx4 a[240:243], v25, s[24:27], 0 offen offset:256
  buffer_load_dwordx4 a[244:247], v25, s[24:27], 0 offen offset:384
  v_add_u32 v3, 0x0, v1
  global_load_dwordx4 v[64:67], v3, s[14:15] offset:0
  global_load_dwordx4 v[68:71], v3, s[14:15] offset:512
  global_load_dwordx4 v[72:75], v3, s[14:15] offset:1024
  global_load_dwordx4 v[76:79], v3, s[14:15] offset:1536
  global_load_dwordx4 v[80:83], v3, s[14:15] offset:2048
  global_load_dwordx4 v[84:87], v3, s[14:15] offset:2560
  global_load_dwordx4 v[88:91], v3, s[14:15] offset:3072
  global_load_dwordx4 v[92:95], v3, s[14:15] offset:3584
  v_add_u32 v3, 0x8000, v1
  global_load_dwordx4 v[96:99], v3, s[14:15] offset:0
  global_load_dwordx4 v[100:103], v3, s[14:15] offset:512
  global_load_dwordx4 v[104:107], v3, s[14:15] offset:1024
  global_load_dwordx4 v[108:111], v3, s[14:15] offset:1536
  global_load_dwordx4 v[112:115], v3, s[14:15] offset:2048
  global_load_dwordx4 v[116:119], v3, s[14:15] offset:2560
  global_load_dwordx4 v[120:123], v3, s[14:15] offset:3072
  global_load_dwordx4 v[124:127], v3, s[14:15] offset:3584
  v_add_u32 v3, 0x10000, v1
  global_load_dwordx4 v[128:131], v3, s[14:15] offset:0
  global_load_dwordx4 v[132:135], v3, s[14:15] offset:512
  global_load_dwordx4 v[136:139], v3, s[14:15] offset:1024
  global_load_dwordx4 v[140:143], v3, s[14:15] offset:1536
  global_load_dwordx4 v[144:147], v3, s[14:15] offset:2048
  global_load_dwordx4 v[148:151], v3, s[14:15] offset:2560
  global_load_dwordx4 v[152:155], v3, s[14:15] offset:3072
  global_load_dwordx4 v[156:159], v3, s[14:15] offset:3584
  v_add_u32 v3, 0x18000, v1
  global_load_dwordx4 v[160:163], v3, s[14:15] offset:0
  global_load_dwordx4 v[164:167], v3, s[14:15] offset:512
  global_load_dwordx4 v[168:171], v3, s[14:15] offset:1024
  global_load_dwordx4 v[172:175], v3, s[14:15] offset:1536
  global_load_dwordx4 v[176:179], v3, s[14:15] offset:2048
  global_load_dwordx4 v[180:183], v3, s[14:15] offset:2560
  global_load_dwordx4 v[184:187], v3, s[14:15] offset:3072
  global_load_dwordx4 v[188:191], v3, s[14:15] offset:3584
  v_mov_b32 v28, 0
  v_mov_b32 v29, 0
  v_mov_b32 v30, 0
  v_mov_b32 v31, 0
  s_nop 1
  v_mfma_f32_32x32x16_bf16 a[200:215], v[28:31], v[28:31], 0
  v_mfma_f32_32x32x16_bf16 a[216:231], v[28:31], v[28:31], 0
  s_nop 3
  s_waitcnt vmcnt(0)
  v_perm_b32 v20, v68, v64, s62
  v_perm_b32 v21, v76, v72, s62
  v_perm_b32 v22, v84, v80, s62
  v_perm_b32 v23, v92, v88, s62
  s_nop 1
  v_mfma_f32_16x16x32_bf16 a[200:203], a[232:235], v[20:23], a[200:203]
  v_perm_b32 v24, v68, v64, s63
  v_perm_b32 v25, v76, v72, s63
  v_perm_b32 v26, v84, v80, s63
  v_perm_b32 v27, v92, v88, s63
  s_nop 1
  v_mfma_f32_16x16x32_bf16 a[204:207], a[232:235], v[24:27], a[204:207]
  v_perm_b32 v28, v69, v65, s62
  v_perm_b32 v29, v77, v73, s62
  v_perm_b32 v30, v85, v81, s62
  v_perm_b32 v31, v93, v89, s62
  s_nop 1
  v_mfma_f32_16x16x32_bf16 a[208:211], a[232:235], v[28:31], a[208:211]
  v_perm_b32 v32, v69, v65, s63
  v_perm_b32 v33, v77, v73, s63
  v_perm_b32 v34, v85, v81, s63
  v_perm_b32 v35, v93, v89, s63
  s_nop 1
  v_mfma_f32_16x16x32_bf16 a[212:215], a[232:235], v[32:35], a[212:215]
  v_perm_b32 v20, v70, v66, s62
  v_perm_b32 v21, v78, v74, s62
  v_perm_b32 v22, v86, v82, s62
  v_perm_b32 v23, v94, v90, s62
  s_nop 1
  v_mfma_f32_16x16x32_bf16 a[216:219], a[232:235], v[20:23], a[216:219]
  v_perm_b32 v24, v70, v66, s63
  v_perm_b32 v25, v78, v74, s63
  v_perm_b32 v26, v86, v82, s63
  v_perm_b32 v27, v94, v90, s63
  s_nop 1
  v_mfma_f32_16x16x32_bf16 a[220:223], a[232:235], v[24:27], a[220:223]
  v_perm_b32 v28, v71, v67, s62
  v_perm_b32 v29, v79, v75, s62
  v_perm_b32 v30, v87, v83, s62
  v_perm_b32 v31, v95, v91, s62
  s_nop 1
  v_mfma_f32_16x16x32_bf16 a[224:227], a[232:235], v[28:31], a[224:227]
  v_perm_b32 v32, v71, v67, s63
  v_perm_b32 v33, v79, v75, s63
  v_perm_b32 v34, v87, v83, s63
  v_perm_b32 v35, v95, v91, s63
  s_nop 1
  v_mfma_f32_16x16x32_bf16 a[228:231], a[232:235], v[32:35], a[228:231]
  v_perm_b32 v20, v100, v96, s62
  v_perm_b32 v21, v108, v104, s62
  v_perm_b32 v22, v116, v112, s62
  v_perm_b32 v23, v124, v120, s62
  s_nop 1
  v_mfma_f32_16x16x32_bf16 a[200:203], a[236:239], v[20:23], a[200:203]
  v_perm_b32 v24, v100, v96, s63
  v_perm_b32 v25, v108, v104, s63
  v_perm_b32 v26, v116, v112, s63
  v_perm_b32 v27, v124, v120, s63
  s_nop 1
  v_mfma_f32_16x16x32_bf16 a[204:207], a[236:239], v[24:27], a[204:207]
  v_perm_b32 v28, v101, v97, s62
  v_perm_b32 v29, v109, v105, s62
  v_perm_b32 v30, v117, v113, s62
  v_perm_b32 v31, v125, v121, s62
  s_nop 1
  v_mfma_f32_16x16x32_bf16 a[208:211], a[236:239], v[28:31], a[208:211]
  v_perm_b32 v32, v101, v97, s63
  v_perm_b32 v33, v109, v105, s63
  v_perm_b32 v34, v117, v113, s63
  v_perm_b32 v35, v125, v121, s63
  s_nop 1
  v_mfma_f32_16x16x32_bf16 a[212:215], a[236:239], v[32:35], a[212:215]
  v_perm_b32 v20, v102, v98, s62
  v_perm_b32 v21, v110, v106, s62
  v_perm_b32 v22, v118, v114, s62
  v_perm_b32 v23, v126, v122, s62
  s_nop 1
  v_mfma_f32_16x16x32_bf16 a[216:219], a[236:239], v[20:23], a[216:219]
  v_perm_b32 v24, v102, v98, s63
  v_perm_b32 v25, v110, v106, s63
  v_perm_b32 v26, v118, v114, s63
  v_perm_b32 v27, v126, v122, s63
  s_nop 1
  v_mfma_f32_16x16x32_bf16 a[220:223], a[236:239], v[24:27], a[220:223]
  v_perm_b32 v28, v103, v99, s62
  v_perm_b32 v29, v111, v107, s62
  v_perm_b32 v30, v119, v115, s62
  v_perm_b32 v31, v127, v123, s62
  s_nop 1
  v_mfma_f32_16x16x32_bf16 a[224:227], a[236:239], v[28:31], a[224:227]
  v_perm_b32 v32, v103, v99, s63
  v_perm_b32 v33, v111, v107, s63
  v_perm_b32 v34, v119, v115, s63
  v_perm_b32 v35, v127, v123, s63
  s_nop 1
  v_mfma_f32_16x16x32_bf16 a[228:231], a[236:239], v[32:35], a[228:231]
  v_perm_b32 v20, v132, v128, s62
  v_perm_b32 v21, v140, v136, s62
  v_perm_b32 v22, v148, v144, s62
  v_perm_b32 v23, v156, v152, s62
  s_nop 1
  v_mfma_f32_16x16x32_bf16 a[200:203], a[240:243], v[20:23], a[200:203]
  v_perm_b32 v24, v132, v128, s63
  v_perm_b32 v25, v140, v136, s63
  v_perm_b32 v26, v148, v144, s63
  v_perm_b32 v27, v156, v152, s63
  s_nop 1
  v_mfma_f32_16x16x32_bf16 a[204:207], a[240:243], v[24:27], a[204:207]
  v_perm_b32 v28, v133, v129, s62
  v_perm_b32 v29, v141, v137, s62
  v_perm_b32 v30, v149, v145, s62
  v_perm_b32 v31, v157, v153, s62
  s_nop 1
  v_mfma_f32_16x16x32_bf16 a[208:211], a[240:243], v[28:31], a[208:211]
  v_perm_b32 v32, v133, v129, s63
  v_perm_b32 v33, v141, v137, s63
  v_perm_b32 v34, v149, v145, s63
  v_perm_b32 v35, v157, v153, s63
  s_nop 1
  v_mfma_f32_16x16x32_bf16 a[212:215], a[240:243], v[32:35], a[212:215]
  v_perm_b32 v20, v134, v130, s62
  v_perm_b32 v21, v142, v138, s62
  v_perm_b32 v22, v150, v146, s62
  v_perm_b32 v23, v158, v154, s62
  s_nop 1
  v_mfma_f32_16x16x32_bf16 a[216:219], a[240:243], v[20:23], a[216:219]
  v_perm_b32 v24, v134, v130, s63
  v_perm_b32 v25, v142, v138, s63
  v_perm_b32 v26, v150, v146, s63
  v_perm_b32 v27, v158, v154, s63
  s_nop 1
  v_mfma_f32_16x16x32_bf16 a[220:223], a[240:243], v[24:27], a[220:223]
  v_perm_b32 v28, v135, v131, s62
  v_perm_b32 v29, v143, v139, s62
  v_perm_b32 v30, v151, v147, s62
  v_perm_b32 v31, v159, v155, s62
  s_nop 1
  v_mfma_f32_16x16x32_bf16 a[224:227], a[240:243], v[28:31], a[224:227]
  v_perm_b32 v32, v135, v131, s63
  v_perm_b32 v33, v143, v139, s63
  v_perm_b32 v34, v151, v147, s63
  v_perm_b32 v35, v159, v155, s63
  s_nop 1
  v_mfma_f32_16x16x32_bf16 a[228:231], a[240:243], v[32:35], a[228:231]
  v_perm_b32 v20, v164, v160, s62
  v_perm_b32 v21, v172, v168, s62
  v_perm_b32 v22, v180, v176, s62
  v_perm_b32 v23, v188, v184, s62
  s_nop 1
  v_mfma_f32_16x16x32_bf16 a[200:203], a[244:247], v[20:23], a[200:203]
  v_perm_b32 v24, v164, v160, s63
  v_perm_b32 v25, v172, v168, s63
  v_perm_b32 v26, v180, v176, s63
  v_perm_b32 v27, v188, v184, s63
  s_nop 1
  v_mfma_f32_16x16x32_bf16 a[204:207], a[244:247], v[24:27], a[204:207]
  v_perm_b32 v28, v165, v161, s62
  v_perm_b32 v29, v173, v169, s62
  v_perm_b32 v30, v181, v177, s62
  v_perm_b32 v31, v189, v185, s62
  s_nop 1
  v_mfma_f32_16x16x32_bf16 a[208:211], a[244:247], v[28:31], a[208:211]
  v_perm_b32 v32, v165, v161, s63
  v_perm_b32 v33, v173, v169, s63
  v_perm_b32 v34, v181, v177, s63
  v_perm_b32 v35, v189, v185, s63
  s_nop 1
  v_mfma_f32_16x16x32_bf16 a[212:215], a[244:247], v[32:35], a[212:215]
  v_perm_b32 v20, v166, v162, s62
  v_perm_b32 v21, v174, v170, s62
  v_perm_b32 v22, v182, v178, s62
  v_perm_b32 v23, v190, v186, s62
  s_nop 1
  v_mfma_f32_16x16x32_bf16 a[216:219], a[244:247], v[20:23], a[216:219]
  v_perm_b32 v24, v166, v162, s63
  v_perm_b32 v25, v174, v170, s63
  v_perm_b32 v26, v182, v178, s63
  v_perm_b32 v27, v190, v186, s63
  s_nop 1
  v_mfma_f32_16x16x32_bf16 a[220:223], a[244:247], v[24:27], a[220:223]
  v_perm_b32 v28, v167, v163, s62
  v_perm_b32 v29, v175, v171, s62
  v_perm_b32 v30, v183, v179, s62
  v_perm_b32 v31, v191, v187, s62
  s_nop 1
  v_mfma_f32_16x16x32_bf16 a[224:227], a[244:247], v[28:31], a[224:227]
  v_perm_b32 v32, v167, v163, s63
  v_perm_b32 v33, v175, v171, s63
  v_perm_b32 v34, v183, v179, s63
  v_perm_b32 v35, v191, v187, s63
  s_nop 1
  v_mfma_f32_16x16x32_bf16 a[228:231], a[244:247], v[32:35], a[228:231]
  s_nop 7
  s_nop 1
  ds_write_b128 v7, a[200:203] offset:0
  ds_write_b128 v7, a[204:207] offset:1024
  ds_write_b128 v7, a[208:211] offset:2048
  ds_write_b128 v7, a[212:215] offset:3072
  ds_write_b128 v7, a[216:219] offset:4096
  ds_write_b128 v7, a[220:223] offset:5120
  ds_write_b128 v7, a[224:227] offset:6144
  ds_write_b128 v7, a[228:231] offset:7168
  v_lshrrev_b32 v20, 4, v14
  v_and_b32 v21, 15, v14
  v_and_b32 v20, 1, v20
  v_lshlrev_b32 v20, 12, v20
  v_lshl_add_u32 v20, v21, 5, v20
  s_lshl_b32 s69, s57, 9
  s_lshl_b32 s70, s2, 14
  s_add_u32 s69, s69, s70
  v_add_u32 v9, s69, v20
  v_add_u32 v4, 0x2000, v9
  v_mov_b32 v10, 0
  s_waitcnt lgkmcnt(0)
  s_barrier
  ds_read_b128 v[20:23], v8 offset:0
  ds_read_b128 v[24:27], v8 offset:1024
  ds_read_b128 v[28:31], v8 offset:2048
  ds_read_b128 v[32:35], v8 offset:3072
  ds_read_b128 v[36:39], v8 offset:4096
  ds_read_b128 v[40:43], v8 offset:5120
  ds_read_b128 v[44:47], v8 offset:6144
  ds_read_b128 v[48:51], v8 offset:7168
  s_waitcnt lgkmcnt(0)
  v_accvgpr_read_b32 v52, a200
  v_accvgpr_read_b32 v53, a201
  v_accvgpr_read_b32 v54, a202
  v_accvgpr_read_b32 v55, a203
  v_pk_add_f32 v[20:21], v[20:21], v[52:53]
  v_pk_add_f32 v[22:23], v[22:23], v[54:55]
  v_cvt_pk_bf16_f32 v52, v20, v21
  v_cvt_pk_bf16_f32 v53, v22, v23
  v_lshlrev_b32 v20, 16, v52
  v_and_b32 v21, 0xffff0000, v52
  v_lshlrev_b32 v22, 16, v53
  v_and_b32 v23, 0xffff0000, v53
  v_mul_f32 v64, s76, v20
  v_mul_f32 v72, s76, v21
  v_mul_f32 v80, s76, v22
  v_mul_f32 v88, s76, v23
  v_max3_f32 v10, |v64|, |v72|, v10
  v_max3_f32 v10, |v80|, |v88|, v10
  v_exp_f32 v96, v64
  v_exp_f32 v104, v72
  v_exp_f32 v112, v80
  v_exp_f32 v120, v88
  v_accvgpr_read_b32 v52, a204
  v_accvgpr_read_b32 v53, a205
  v_accvgpr_read_b32 v54, a206
  v_accvgpr_read_b32 v55, a207
  v_pk_add_f32 v[24:25], v[24:25], v[52:53]
  v_pk_add_f32 v[26:27], v[26:27], v[54:55]
  v_cvt_pk_bf16_f32 v52, v24, v25
  v_cvt_pk_bf16_f32 v53, v26, v27
  v_lshlrev_b32 v24, 16, v52
  v_and_b32 v25, 0xffff0000, v52
  v_lshlrev_b32 v26, 16, v53
  v_and_b32 v27, 0xffff0000, v53
  v_mul_f32 v65, s76, v24
  v_mul_f32 v73, s76, v25
  v_mul_f32 v81, s76, v26
  v_mul_f32 v89, s76, v27
  v_max3_f32 v10, |v65|, |v73|, v10
  v_max3_f32 v10, |v81|, |v89|, v10
  v_exp_f32 v97, v65
  v_exp_f32 v105, v73
  v_exp_f32 v113, v81
  v_exp_f32 v121, v89
  v_accvgpr_read_b32 v52, a208
  v_accvgpr_read_b32 v53, a209
  v_accvgpr_read_b32 v54, a210
  v_accvgpr_read_b32 v55, a211
  v_pk_add_f32 v[28:29], v[28:29], v[52:53]
  v_pk_add_f32 v[30:31], v[30:31], v[54:55]
  v_cvt_pk_bf16_f32 v52, v28, v29
  v_cvt_pk_bf16_f32 v53, v30, v31
  v_lshlrev_b32 v28, 16, v52
  v_and_b32 v29, 0xffff0000, v52
  v_lshlrev_b32 v30, 16, v53
  v_and_b32 v31, 0xffff0000, v53
  v_mul_f32 v66, s76, v28
  v_mul_f32 v74, s76, v29
  v_mul_f32 v82, s76, v30
  v_mul_f32 v90, s76, v31
  v_max3_f32 v10, |v66|, |v74|, v10
  v_max3_f32 v10, |v82|, |v90|, v10
  v_exp_f32 v98, v66
  v_exp_f32 v106, v74
  v_exp_f32 v114, v82
  v_exp_f32 v122, v90
  v_accvgpr_read_b32 v52, a212
  v_accvgpr_read_b32 v53, a213
  v_accvgpr_read_b32 v54, a214
  v_accvgpr_read_b32 v55, a215
  v_pk_add_f32 v[32:33], v[32:33], v[52:53]
  v_pk_add_f32 v[34:35], v[34:35], v[54:55]
  v_cvt_pk_bf16_f32 v52, v32, v33
  v_cvt_pk_bf16_f32 v53, v34, v35
  v_lshlrev_b32 v32, 16, v52
  v_and_b32 v33, 0xffff0000, v52
  v_lshlrev_b32 v34, 16, v53
  v_and_b32 v35, 0xffff0000, v53
  v_mul_f32 v67, s76, v32
  v_mul_f32 v75, s76, v33
  v_mul_f32 v83, s76, v34
  v_mul_f32 v91, s76, v35
  v_max3_f32 v10, |v67|, |v75|, v10
  v_max3_f32 v10, |v83|, |v91|, v10
  v_exp_f32 v99, v67
  v_exp_f32 v107, v75
  v_exp_f32 v115, v83
  v_exp_f32 v123, v91
  v_accvgpr_read_b32 v52, a216
  v_accvgpr_read_b32 v53, a217
  v_accvgpr_read_b32 v54, a218
  v_accvgpr_read_b32 v55, a219
  v_pk_add_f32 v[36:37], v[36:37], v[52:53]
  v_pk_add_f32 v[38:39], v[38:39], v[54:55]
  v_cvt_pk_bf16_f32 v52, v36, v37
  v_cvt_pk_bf16_f32 v53, v38, v39
  v_lshlrev_b32 v36, 16, v52
  v_and_b32 v37, 0xffff0000, v52
  v_lshlrev_b32 v38, 16, v53
  v_and_b32 v39, 0xffff0000, v53
  v_mul_f32 v68, s76, v36
  v_mul_f32 v76, s76, v37
  v_mul_f32 v84, s76, v38
  v_mul_f32 v92, s76, v39
  v_max3_f32 v10, |v68|, |v76|, v10
  v_max3_f32 v10, |v84|, |v92|, v10
  v_exp_f32 v100, v68
  v_exp_f32 v108, v76
  v_exp_f32 v116, v84
  v_exp_f32 v124, v92
  v_accvgpr_read_b32 v52, a220
  v_accvgpr_read_b32 v53, a221
  v_accvgpr_read_b32 v54, a222
  v_accvgpr_read_b32 v55, a223
  v_pk_add_f32 v[40:41], v[40:41], v[52:53]
  v_pk_add_f32 v[42:43], v[42:43], v[54:55]
  v_cvt_pk_bf16_f32 v52, v40, v41
  v_cvt_pk_bf16_f32 v53, v42, v43
  v_lshlrev_b32 v40, 16, v52
  v_and_b32 v41, 0xffff0000, v52
  v_lshlrev_b32 v42, 16, v53
  v_and_b32 v43, 0xffff0000, v53
  v_mul_f32 v69, s76, v40
  v_mul_f32 v77, s76, v41
  v_mul_f32 v85, s76, v42
  v_mul_f32 v93, s76, v43
  v_max3_f32 v10, |v69|, |v77|, v10
  v_max3_f32 v10, |v85|, |v93|, v10
  v_exp_f32 v101, v69
  v_exp_f32 v109, v77
  v_exp_f32 v117, v85
  v_exp_f32 v125, v93
  v_accvgpr_read_b32 v52, a224
  v_accvgpr_read_b32 v53, a225
  v_accvgpr_read_b32 v54, a226
  v_accvgpr_read_b32 v55, a227
  v_pk_add_f32 v[44:45], v[44:45], v[52:53]
  v_pk_add_f32 v[46:47], v[46:47], v[54:55]
  v_cvt_pk_bf16_f32 v52, v44, v45
  v_cvt_pk_bf16_f32 v53, v46, v47
  v_lshlrev_b32 v44, 16, v52
  v_and_b32 v45, 0xffff0000, v52
  v_lshlrev_b32 v46, 16, v53
  v_and_b32 v47, 0xffff0000, v53
  v_mul_f32 v70, s76, v44
  v_mul_f32 v78, s76, v45
  v_mul_f32 v86, s76, v46
  v_mul_f32 v94, s76, v47
  v_max3_f32 v10, |v70|, |v78|, v10
  v_max3_f32 v10, |v86|, |v94|, v10
  v_exp_f32 v102, v70
  v_exp_f32 v110, v78
  v_exp_f32 v118, v86
  v_exp_f32 v126, v94
  v_accvgpr_read_b32 v52, a228
  v_accvgpr_read_b32 v53, a229
  v_accvgpr_read_b32 v54, a230
  v_accvgpr_read_b32 v55, a231
  v_pk_add_f32 v[48:49], v[48:49], v[52:53]
  v_pk_add_f32 v[50:51], v[50:51], v[54:55]
  v_cvt_pk_bf16_f32 v52, v48, v49
  v_cvt_pk_bf16_f32 v53, v50, v51
  v_lshlrev_b32 v48, 16, v52
  v_and_b32 v49, 0xffff0000, v52
  v_lshlrev_b32 v50, 16, v53
  v_and_b32 v51, 0xffff0000, v53
  v_mul_f32 v71, s76, v48
  v_mul_f32 v79, s76, v49
  v_mul_f32 v87, s76, v50
  v_mul_f32 v95, s76, v51
  v_max3_f32 v10, |v71|, |v79|, v10
  v_max3_f32 v10, |v87|, |v95|, v10
  v_exp_f32 v103, v71
  v_exp_f32 v111, v79
  v_exp_f32 v119, v87
  v_exp_f32 v127, v95
  v_mov_b32 v52, 0x42fa0000
  s_mov_b32 exec_hi, 0
  v_cmp_nle_f32 vcc, v10, v52
  global_store_dwordx4 v9, v[96:99], s[80:81] offset:0 sc0 sc1
  global_store_dwordx4 v4, v[64:67], s[80:81] offset:0 sc0 sc1
  global_store_dwordx4 v9, v[100:103], s[80:81] offset:16 sc0 sc1
  global_store_dwordx4 v4, v[68:71], s[80:81] offset:16 sc0 sc1
  global_store_dwordx4 v9, v[104:107], s[80:81] offset:1024 sc0 sc1
  global_store_dwordx4 v4, v[72:75], s[80:81] offset:1024 sc0 sc1
  global_store_dwordx4 v9, v[108:111], s[80:81] offset:1040 sc0 sc1
  global_store_dwordx4 v4, v[76:79], s[80:81] offset:1040 sc0 sc1
  global_store_dwordx4 v9, v[112:115], s[80:81] offset:2048 sc0 sc1
  global_store_dwordx4 v4, v[80:83], s[80:81] offset:2048 sc0 sc1
  global_store_dwordx4 v9, v[116:119], s[80:81] offset:2064 sc0 sc1
  global_store_dwordx4 v4, v[84:87], s[80:81] offset:2064 sc0 sc1
  global_store_dwordx4 v9, v[120:123], s[80:81] offset:3072 sc0 sc1
  global_store_dwordx4 v4, v[88:91], s[80:81] offset:3072 sc0 sc1
  global_store_dwordx4 v9, v[124:127], s[80:81] offset:3088 sc0 sc1
  global_store_dwordx4 v4, v[92:95], s[80:81] offset:3088 sc0 sc1
  s_mov_b64 exec, -1
  s_or_b32 s68, vcc_lo, vcc_hi
  s_cmp_lg_u32 s68, 0
  s_cselect_b32 s68, 3, 1
  s_lshl_b32 s69, s2, 4
  s_lshl_b32 s70, s56, 2
  s_add_u32 s69, s69, s70
  v_mov_b32 v20, s69
  v_mov_b32 v21, s68
  s_waitcnt vmcnt(0)
  s_mov_b32 exec_lo, 1
  s_mov_b32 exec_hi, 0
  global_store_dword v20, v21, s[84:85] sc0 sc1
  s_endpgm
L_end:
  s_endpgm
  s_endpgm
  s_endpgm
  s_endpgm
  s_endpgm
  s_endpgm
  s_endpgm
  s_endpgm
  s_endpgm
  s_endpgm
  s_endpgm
  s_endpgm
  s_endpgm
  s_endpgm
  s_endpgm
  s_endpgm
  s_endpgm
  s_endpgm
  s_endpgm
  s_endpgm
  s_endpgm
  s_endpgm
  s_endpgm
  s_endpgm
  s_endpgm
  s_endpgm
  s_endpgm
  s_endpgm
  s_endpgm
  s_endpgm
  s_endpgm
  s_endpgm
  s_endpgm
  s_endpgm
  s_endpgm
  s_endpgm
  s_endpgm
  s_endpgm
  s_endpgm
  s_endpgm
  s_endpgm
  s_endpgm
  s_endpgm
  s_endpgm
  s_endpgm
  s_endpgm
  s_endpgm
  s_endpgm
  s_endpgm
  s_endpgm
  s_endpgm
  s_endpgm
  s_endpgm
  s_endpgm
  s_endpgm
  s_endpgm
  s_endpgm
  s_endpgm
  s_endpgm
  s_endpgm
  s_endpgm
  s_endpgm
  s_endpgm
  s_endpgm
  s_endpgm
  s_endpgm
  s_endpgm
  s_endpgm
  s_endpgm
  s_endpgm
  s_endpgm
  s_endpgm
  s_endpgm
  s_endpgm
  s_endpgm
  s_endpgm
  s_endpgm
  s_endpgm
  s_endpgm
  s_endpgm
  s_endpgm
  s_endpgm
  s_endpgm
  s_endpgm
  s_endpgm
  s_endpgm
  s_endpgm
  s_endpgm
  s_endpgm
  s_endpgm
  s_endpgm
  s_endpgm
  s_endpgm
  s_endpgm
  s_endpgm
  s_endpgm
  s_endpgm
  s_endpgm
  s_endpgm
  s_endpgm
  s_endpgm
  s_endpgm
  s_endpgm
  s_endpgm
  s_endpgm
  s_endpgm
  s_endpgm
  s_endpgm
  s_endpgm
  s_endpgm
  s_endpgm
  s_endpgm
  s_endpgm
  s_endpgm
  s_endpgm
  s_endpgm
  s_endpgm
  s_endpgm
  s_endpgm
  s_endpgm
  s_endpgm
  s_endpgm
  s_endpgm
  s_endpgm
  s_endpgm
  s_endpgm
  s_endpgm
  s_endpgm
  s_endpgm
  s_endpgm
  s_endpgm
  s_endpgm
  s_endpgm
  s_endpgm
  s_endpgm
  s_endpgm
  s_endpgm
  s_endpgm
  s_endpgm
  s_endpgm
  s_endpgm
  s_endpgm
  s_endpgm
  s_endpgm
  s_endpgm
  s_endpgm
  s_endpgm
  s_endpgm
  s_endpgm
  s_endpgm
  s_endpgm
  s_endpgm
  s_endpgm
  s_endpgm
  s_endpgm
  s_endpgm
  s_endpgm
  s_endpgm
  s_endpgm
  s_endpgm
  s_endpgm
  s_endpgm
  s_endpgm
  s_endpgm
  s_endpgm
  s_endpgm
  s_endpgm
  s_endpgm
  s_endpgm
  s_endpgm
  s_endpgm
  s_endpgm
  s_endpgm
  s_endpgm
  s_endpgm
  s_endpgm
  s_endpgm
  s_endpgm
  s_endpgm
  s_endpgm
  s_endpgm
  s_endpgm
  s_endpgm
  s_endpgm
  s_endpgm
  s_endpgm
  s_endpgm
  s_endpgm
  s_endpgm
  s_endpgm
  s_endpgm
  s_endpgm
  s_endpgm
  s_endpgm
  s_endpgm
  s_endpgm
  s_endpgm
  s_endpgm
  s_endpgm
  s_endpgm
  s_endpgm
  s_endpgm
  s_endpgm
  s_endpgm
  s_endpgm
  s_endpgm
  s_endpgm
  s_endpgm
  s_endpgm
  s_endpgm
  s_endpgm
  s_endpgm
  s_endpgm
  s_endpgm
  s_endpgm
  s_endpgm
  s_endpgm
  s_endpgm
  s_endpgm
  s_endpgm
  s_endpgm
  s_endpgm
  s_endpgm
  s_endpgm
  s_endpgm
  s_endpgm
  s_endpgm
  s_endpgm
  s_endpgm
  s_endpgm
  s_endpgm
  s_endpgm
  s_endpgm
  s_endpgm
  s_endpgm
  s_endpgm
  s_endpgm
  s_endpgm
  s_endpgm
  s_endpgm
  s_endpgm
  s_endpgm
  s_endpgm
  s_endpgm
  s_endpgm
  s_endpgm
  s_endpgm
  s_endpgm
  s_endpgm
  s_endpgm
  s_endpgm
  s_endpgm
  s_endpgm
  s_endpgm
  s_endpgm
  s_endpgm
  s_endpgm
  s_endpgm
  s_endpgm
  s_endpgm
  s_endpgm
  s_endpgm
  s_endpgm
  s_endpgm
  s_endpgm
  s_endpgm
  s_endpgm
  s_endpgm
  s_endpgm
  s_endpgm
  s_endpgm
  s_endpgm
  s_endpgm
  s_endpgm
  s_endpgm
  s_endpgm
  s_endpgm
  s_endpgm
  s_endpgm
  s_endpgm
  s_endpgm
  s_endpgm
  s_endpgm
  s_endpgm
  s_endpgm
  s_endpgm
  s_endpgm
  s_endpgm
  s_endpgm
  s_endpgm
  s_endpgm
  s_endpgm
  s_endpgm
  s_endpgm
  s_endpgm
  s_endpgm
  s_endpgm
  s_endpgm
  s_endpgm
  s_endpgm
  s_endpgm
.section .rodata,"a"
.p2align 6
.amdhsa_kernel standalone__seq2seq_rnn_t_joint__speech_kernel
  .amdhsa_next_free_vgpr 512
  .amdhsa_next_free_sgpr 102
  .amdhsa_accum_offset 256
  .amdhsa_group_segment_fixed_size 0
  .amdhsa_kernarg_size 80
  .amdhsa_user_sgpr_count 2
  .amdhsa_user_sgpr_kernarg_segment_ptr 1
  .amdhsa_system_sgpr_workgroup_id_x 1
.end_amdhsa_kernel
```
